```python
import torch

def _softmax(x, axis=-1):
    return torch.softmax(x, dim=axis)
def _gelu(x):
    return torch.nn.functional.gelu(x, approximate="tanh")
def _silu(x):
    return torch.nn.functional.silu(x)
def _sigmoid(x):
    return torch.sigmoid(x)
def _layernorm(x, axis=-1, eps=1e-5):
    m = x.mean(dim=axis, keepdim=True)
    v = x.var(dim=axis, keepdim=True, unbiased=False)
    return (x - m) / torch.sqrt(v + eps)
def _scatter_add(tgt, idx, src, axis=0):
    return tgt.clone().index_add_(axis, idx, src)
def _segment_sum(src, seg, n):
    out = torch.zeros((n,) + src.shape[1:], dtype=src.dtype)
    return out.index_add_(0, seg, src)
def _pad(x, pw):
    flat = tuple(v for pair in reversed(pw) for v in pair)
    return torch.nn.functional.pad(x, flat)

kernel_name = 'sequential_preLN__linear_attn_block__dense_activation_squared_relu__prompt'

def setup_inputs():

    _w = (lambda a: (lambda t: t.to(torch.bfloat16) if t.is_floating_point() else t)(torch.as_tensor(a)))
    def _A_setup():
        B, S, D = 1, 2048, 640
        return {
            "x": _w((lambda *s: torch.randn(*s, dtype=torch.bfloat16) * 0.05)(B, S, D)),
            "wqkv": _w((lambda *s: torch.randn(*s, dtype=torch.bfloat16) * 0.1)(D, 3 * D)),
            "wo": _w((lambda *s: torch.randn(*s, dtype=torch.bfloat16) * 0.05)(D, D)),
        }
    _A_in = _A_setup()

    def _B_setup():
        B, S, D, F = 1, 2048, 640, 1536
        return {
            "x": _w((lambda *s: torch.randn(*s, dtype=torch.bfloat16) * 0.05)(B, S, D)),
            "w1": _w((lambda *s: torch.randn(*s, dtype=torch.bfloat16) * 0.05)(D, F)),
            "b1": _w((lambda *s: torch.randn(*s, dtype=torch.bfloat16) * 0.4)(F)),
            "w2": _w((lambda *s: torch.randn(*s, dtype=torch.bfloat16) * 0.05)(F, D)),
            "b2": _w((lambda *s: torch.randn(*s, dtype=torch.bfloat16) * 1.6)(D)),
        }
    _B_in = _B_setup()

    return {
        "A_x": _A_in["x"],
        "A_wqkv": _A_in["wqkv"],
        "A_wo": _A_in["wo"],
        "B_x": _B_in["x"],
        "B_w1": _B_in["w1"],
        "B_b1": _B_in["b1"],
        "B_w2": _B_in["w2"],
        "B_b2": _B_in["b2"],
    }

def reference(A_x, A_wqkv, A_wo, B_x, B_w1, B_b1, B_w2, B_b2):
    def _A_ref(x, wqkv, wo):
        B, S, D = x.shape
        H = 32; Dh = D // H
        qkv = (lambda x, *d: x.permute(*d))((x @ wqkv).reshape(B, S, 3, H, Dh), 2, 0, 3, 1, 4)
        q, k, v = qkv[0], qkv[1], qkv[2]
        phi = lambda t: torch.where(t > 0, t + 1, torch.exp(t)) + 1e-6
        pq, pk = phi(q), phi(k)
        kv = torch.einsum("bhsd,bhse->bhde", pk, v)
        z = torch.einsum("bhsd->bhd", pk)
        num = torch.einsum("bhqd,bhde->bhqe", pq, kv)
        den = torch.einsum("bhqd,bhd->bhq", pq, z)[..., None] + 1e-6
        o = num / den
        return (lambda x, *d: x.permute(*d))(o, 0, 2, 1, 3).reshape(B, S, D) @ wo

    def _B_ref(x, w1, b1, w2, b2):
        h = torch.einsum("bsd,df->bsf", x, w1) + b1
        zero = torch.zeros_like(h)
        r = torch.where(h > zero, h, zero)
        h = r * r
        out = torch.einsum("bsf,fd->bsd", h, w2) + b2
        return out

    x = A_x
    h = x + _A_ref(_layernorm(x, axis=-1), A_wqkv, A_wo)
    h2 = h + _B_ref(_layernorm(h, axis=-1), B_w1, B_b1, B_w2, B_b2)
    return h2
```

```asm
; @launch grid=(256,1,1) block=(256,1,1) lds=163840
.amdgcn_target "amdgcn-amd-amdhsa--gfx950"
.text
.globl sequential_preLN__linear_attn_block__dense_activation_squared_relu__prompt_kernel
.p2align 8
.type sequential_preLN__linear_attn_block__dense_activation_squared_relu__prompt_kernel,@function
sequential_preLN__linear_attn_block__dense_activation_squared_relu__prompt_kernel:
    s_load_dwordx16 s[48:63], s[0:1], 0
    s_load_dwordx2 s[14:15], s[0:1], 80
    s_load_dwordx2 s[46:47], s[0:1], 64
    s_getpc_b64 s[4:5]
pcl:
    s_cmp_ge_u32 s2, 256
    s_cbranch_scc1 kend
    s_lshr_b32 s25, s2, 3
    s_and_b32 s6, s25, 7
    s_lshl_b32 s6, s6, 13
    v_lshl_add_u32 v30, v0, 7, s6
    v_min_u32 v30, kend-pcl, v30
    v_cmp_gt_u32 vcc, 64, v0
    v_and_b32 v1, 63, v0
    v_lshrrev_b32 v2, 6, v0
    s_and_saveexec_b64 s[6:7], vcc
    s_cbranch_execz p0_nopf
    global_load_dword v31, v30, s[4:5]
p0_nopf:
    s_mov_b64 exec, s[6:7]
    v_lshlrev_b32 v3, 4, v1
    v_readfirstlane_b32 s20, v2
    s_and_b32 s24, s2, 7
    s_lshr_b32 s26, s24, 1
    s_lshl_b32 s26, s26, 2
    s_lshr_b32 s27, s25, 3
    s_add_u32 s26, s26, s27
    s_and_b32 s27, s24, 1
    s_lshl_b32 s27, s27, 3
    s_and_b32 s25, s25, 7
    s_add_u32 s27, s27, s25
    s_lshl_b32 s45, s26, 4
    s_add_u32 s45, s45, s27
    v_bfe_u32 v28, v1, 2, 2
    v_and_b32 v29, 3, v1
    v_mov_b32 v228, 0
    s_cmp_ge_u32 s45, 128
    s_cbranch_scc1 p0_w
    v_lshrrev_b32 v4, 4, v0
    v_and_b32 v5, 15, v0
    s_lshl_b32 s21, s45, 4
    v_add_u32 v6, s21, v4
    v_mul_u32_u24 v6, 1280, v6
    v_lshl_add_u32 v6, v5, 4, v6
    s_mov_b32 s10, 2621440
    s_mov_b32 s11, 0x20000
    s_waitcnt lgkmcnt(0)
    s_mov_b32 s8, s48
    s_mov_b32 s9, s49
    buffer_load_dwordx4 v[208:211], v6, s[8:11], 0 offen offset:0 nt
    buffer_load_dwordx4 v[212:215], v6, s[8:11], 0 offen offset:256 nt
    buffer_load_dwordx4 v[216:219], v6, s[8:11], 0 offen offset:512 nt
    buffer_load_dwordx4 v[220:223], v6, s[8:11], 0 offen offset:768 nt
    buffer_load_dwordx4 v[224:227], v6, s[8:11], 0 offen offset:1024 nt
    s_load_dword s44, s[14:15], 0
    s_mov_b32 s16, s14
    s_mov_b32 s17, s15
    s_mov_b32 s18, 28311552
    s_mov_b32 s19, 0x20000
    s_lshr_b32 s21, s45, 1
    s_mul_i32 s21, s21, 40960
    s_and_b32 s22, s45, 1
    s_lshl_b32 s22, s22, 8
    s_add_u32 s21, s21, s22
    s_add_u32 s21, s21, 1048576
    v_lshrrev_b32 v7, 1, v5
    v_lshlrev_b32 v7, 10, v7
    v_and_b32 v6, 1, v5
    v_lshlrev_b32 v6, 9, v6
    v_lshl_add_u32 v7, v4, 4, v7
    v_add_u32 v7, v7, v6
    s_mov_b32 s23, 0xffff0000
    s_mov_b32 s22, 0x3f803f80
    v_mov_b32 v112, 0
    v_mov_b32 v113, 0
    v_mov_b32 v114, 0
    v_mov_b32 v115, 0
    v_lshrrev_b32 v30, 4, v1
    s_waitcnt vmcnt(4)
    v_dot2_f32_bf16 v112, v208, s22, v112
    v_dot2_f32_bf16 v113, v208, v208, v113
    v_dot2_f32_bf16 v114, v209, s22, v114
    v_dot2_f32_bf16 v115, v209, v209, v115
    v_dot2_f32_bf16 v112, v210, s22, v112
    v_dot2_f32_bf16 v113, v210, v210, v113
    v_dot2_f32_bf16 v114, v211, s22, v114
    v_dot2_f32_bf16 v115, v211, v211, v115
    s_waitcnt vmcnt(3)
    v_dot2_f32_bf16 v112, v212, s22, v112
    v_dot2_f32_bf16 v113, v212, v212, v113
    v_dot2_f32_bf16 v114, v213, s22, v114
    v_dot2_f32_bf16 v115, v213, v213, v115
    v_dot2_f32_bf16 v112, v214, s22, v112
    v_dot2_f32_bf16 v113, v214, v214, v113
    v_dot2_f32_bf16 v114, v215, s22, v114
    v_dot2_f32_bf16 v115, v215, v215, v115
    s_waitcnt vmcnt(2)
    v_dot2_f32_bf16 v112, v216, s22, v112
    v_dot2_f32_bf16 v113, v216, v216, v113
    v_dot2_f32_bf16 v114, v217, s22, v114
    v_dot2_f32_bf16 v115, v217, v217, v115
    v_dot2_f32_bf16 v112, v218, s22, v112
    v_dot2_f32_bf16 v113, v218, v218, v113
    v_dot2_f32_bf16 v114, v219, s22, v114
    v_dot2_f32_bf16 v115, v219, v219, v115
    s_waitcnt vmcnt(1)
    v_dot2_f32_bf16 v112, v220, s22, v112
    v_dot2_f32_bf16 v113, v220, v220, v113
    v_dot2_f32_bf16 v114, v221, s22, v114
    v_dot2_f32_bf16 v115, v221, v221, v115
    v_dot2_f32_bf16 v112, v222, s22, v112
    v_dot2_f32_bf16 v113, v222, v222, v113
    v_dot2_f32_bf16 v114, v223, s22, v114
    v_dot2_f32_bf16 v115, v223, v223, v115
    s_waitcnt vmcnt(0)
    v_dot2_f32_bf16 v112, v224, s22, v112
    v_dot2_f32_bf16 v113, v224, v224, v113
    v_dot2_f32_bf16 v114, v225, s22, v114
    v_dot2_f32_bf16 v115, v225, v225, v115
    v_dot2_f32_bf16 v112, v226, s22, v112
    v_dot2_f32_bf16 v113, v226, v226, v113
    v_dot2_f32_bf16 v114, v227, s22, v114
    v_dot2_f32_bf16 v115, v227, v227, v115
    v_lshlrev_b32 v32, 16, v208
    v_and_b32 v33, s23, v208
    v_lshlrev_b32 v34, 16, v209
    v_pk_add_f32 v[112:113], v[112:113], v[114:115]
    v_and_b32 v35, s23, v209
    v_lshlrev_b32 v36, 16, v210
    v_add_f32_dpp v112, v112, v112 row_ror:8 row_mask:0xf bank_mask:0xf
    v_add_f32_dpp v113, v113, v113 row_ror:8 row_mask:0xf bank_mask:0xf
    v_and_b32 v37, s23, v210
    v_lshlrev_b32 v38, 16, v211
    v_add_f32_dpp v112, v112, v112 row_ror:4 row_mask:0xf bank_mask:0xf
    v_add_f32_dpp v113, v113, v113 row_ror:4 row_mask:0xf bank_mask:0xf
    v_and_b32 v39, s23, v211
    v_lshlrev_b32 v40, 16, v212
    v_add_f32_dpp v112, v112, v112 row_ror:2 row_mask:0xf bank_mask:0xf
    v_add_f32_dpp v113, v113, v113 row_ror:2 row_mask:0xf bank_mask:0xf
    v_and_b32 v41, s23, v212
    v_lshlrev_b32 v42, 16, v213
    v_add_f32_dpp v112, v112, v112 row_ror:1 row_mask:0xf bank_mask:0xf
    v_add_f32_dpp v113, v113, v113 row_ror:1 row_mask:0xf bank_mask:0xf
    v_mul_f32 v112, 0x3acccccd, v112
    v_mul_f32 v113, 0x3acccccd, v113
    v_fma_f32 v113, -v112, v112, v113
    v_max_f32 v113, 0, v113
    v_cvt_pk_bf16_f32 v112, v112, v112
    v_lshlrev_b32 v112, 16, v112
    v_cvt_pk_bf16_f32 v113, v113, v113
    v_lshlrev_b32 v113, 16, v113
    v_add_f32 v113, 0x3727c5ac, v113
    v_cvt_pk_bf16_f32 v113, v113, v113
    v_lshlrev_b32 v113, 16, v113
    v_sqrt_f32 v113, v113
    v_and_b32 v43, s23, v213
    v_cvt_pk_bf16_f32 v113, v113, v113
    v_lshlrev_b32 v113, 16, v113
    v_rcp_f32 v114, v113
    v_lshlrev_b32 v44, 16, v214
    v_and_b32 v45, s23, v214
    v_lshlrev_b32 v46, 16, v215
    v_and_b32 v47, s23, v215
    v_lshlrev_b32 v48, 16, v216
    v_and_b32 v49, s23, v216
    v_lshlrev_b32 v50, 16, v217
    v_and_b32 v51, s23, v217
    v_lshlrev_b32 v52, 16, v218
    v_and_b32 v53, s23, v218
    v_lshlrev_b32 v54, 16, v219
    v_and_b32 v55, s23, v219
    v_lshlrev_b32 v56, 16, v220
    v_and_b32 v57, s23, v220
    v_lshlrev_b32 v58, 16, v221
    v_and_b32 v59, s23, v221
    v_lshlrev_b32 v60, 16, v222
    v_and_b32 v61, s23, v222
    v_lshlrev_b32 v62, 16, v223
    v_and_b32 v63, s23, v223
    v_lshlrev_b32 v64, 16, v224
    v_and_b32 v65, s23, v224
    v_lshlrev_b32 v66, 16, v225
    v_and_b32 v67, s23, v225
    v_lshlrev_b32 v68, 16, v226
    v_and_b32 v69, s23, v226
    v_lshlrev_b32 v70, 16, v227
    v_and_b32 v71, s23, v227
    v_pk_add_f32 v[32:33], v[32:33], v[112:113] op_sel_hi:[1,0] neg_lo:[0,1] neg_hi:[0,1]
    v_pk_add_f32 v[34:35], v[34:35], v[112:113] op_sel_hi:[1,0] neg_lo:[0,1] neg_hi:[0,1]
    v_pk_add_f32 v[36:37], v[36:37], v[112:113] op_sel_hi:[1,0] neg_lo:[0,1] neg_hi:[0,1]
    v_pk_add_f32 v[38:39], v[38:39], v[112:113] op_sel_hi:[1,0] neg_lo:[0,1] neg_hi:[0,1]
    v_pk_add_f32 v[40:41], v[40:41], v[112:113] op_sel_hi:[1,0] neg_lo:[0,1] neg_hi:[0,1]
    v_pk_add_f32 v[42:43], v[42:43], v[112:113] op_sel_hi:[1,0] neg_lo:[0,1] neg_hi:[0,1]
    v_pk_add_f32 v[44:45], v[44:45], v[112:113] op_sel_hi:[1,0] neg_lo:[0,1] neg_hi:[0,1]
    v_pk_add_f32 v[46:47], v[46:47], v[112:113] op_sel_hi:[1,0] neg_lo:[0,1] neg_hi:[0,1]
    v_pk_add_f32 v[48:49], v[48:49], v[112:113] op_sel_hi:[1,0] neg_lo:[0,1] neg_hi:[0,1]
    v_pk_add_f32 v[50:51], v[50:51], v[112:113] op_sel_hi:[1,0] neg_lo:[0,1] neg_hi:[0,1]
    v_pk_add_f32 v[52:53], v[52:53], v[112:113] op_sel_hi:[1,0] neg_lo:[0,1] neg_hi:[0,1]
    v_pk_add_f32 v[54:55], v[54:55], v[112:113] op_sel_hi:[1,0] neg_lo:[0,1] neg_hi:[0,1]
    v_pk_add_f32 v[56:57], v[56:57], v[112:113] op_sel_hi:[1,0] neg_lo:[0,1] neg_hi:[0,1]
    v_pk_add_f32 v[58:59], v[58:59], v[112:113] op_sel_hi:[1,0] neg_lo:[0,1] neg_hi:[0,1]
    v_pk_add_f32 v[60:61], v[60:61], v[112:113] op_sel_hi:[1,0] neg_lo:[0,1] neg_hi:[0,1]
    v_pk_add_f32 v[62:63], v[62:63], v[112:113] op_sel_hi:[1,0] neg_lo:[0,1] neg_hi:[0,1]
    v_pk_add_f32 v[64:65], v[64:65], v[112:113] op_sel_hi:[1,0] neg_lo:[0,1] neg_hi:[0,1]
    v_pk_add_f32 v[66:67], v[66:67], v[112:113] op_sel_hi:[1,0] neg_lo:[0,1] neg_hi:[0,1]
    v_pk_add_f32 v[68:69], v[68:69], v[112:113] op_sel_hi:[1,0] neg_lo:[0,1] neg_hi:[0,1]
    v_pk_add_f32 v[70:71], v[70:71], v[112:113] op_sel_hi:[1,0] neg_lo:[0,1] neg_hi:[0,1]
    v_cvt_pk_bf16_f32 v72, v32, v33
    v_cvt_pk_bf16_f32 v73, v34, v35
    v_cvt_pk_bf16_f32 v74, v36, v37
    v_cvt_pk_bf16_f32 v75, v38, v39
    v_cvt_pk_bf16_f32 v76, v40, v41
    v_cvt_pk_bf16_f32 v77, v42, v43
    v_cvt_pk_bf16_f32 v78, v44, v45
    v_cvt_pk_bf16_f32 v79, v46, v47
    v_cvt_pk_bf16_f32 v80, v48, v49
    v_cvt_pk_bf16_f32 v81, v50, v51
    v_cvt_pk_bf16_f32 v82, v52, v53
    v_cvt_pk_bf16_f32 v83, v54, v55
    v_cvt_pk_bf16_f32 v84, v56, v57
    v_cvt_pk_bf16_f32 v85, v58, v59
    v_cvt_pk_bf16_f32 v86, v60, v61
    v_cvt_pk_bf16_f32 v87, v62, v63
    v_cvt_pk_bf16_f32 v88, v64, v65
    v_cvt_pk_bf16_f32 v89, v66, v67
    v_cvt_pk_bf16_f32 v90, v68, v69
    v_cvt_pk_bf16_f32 v91, v70, v71
    v_lshlrev_b32 v32, 16, v72
    v_and_b32 v33, s23, v72
    v_lshlrev_b32 v34, 16, v73
    v_and_b32 v35, s23, v73
    v_lshlrev_b32 v36, 16, v74
    v_and_b32 v37, s23, v74
    v_lshlrev_b32 v38, 16, v75
    v_and_b32 v39, s23, v75
    v_lshlrev_b32 v40, 16, v76
    v_and_b32 v41, s23, v76
    v_lshlrev_b32 v42, 16, v77
    v_and_b32 v43, s23, v77
    v_lshlrev_b32 v44, 16, v78
    v_and_b32 v45, s23, v78
    v_lshlrev_b32 v46, 16, v79
    v_and_b32 v47, s23, v79
    v_lshlrev_b32 v48, 16, v80
    v_and_b32 v49, s23, v80
    v_lshlrev_b32 v50, 16, v81
    v_and_b32 v51, s23, v81
    v_lshlrev_b32 v52, 16, v82
    v_and_b32 v53, s23, v82
    v_lshlrev_b32 v54, 16, v83
    v_and_b32 v55, s23, v83
    v_lshlrev_b32 v56, 16, v84
    v_and_b32 v57, s23, v84
    v_lshlrev_b32 v58, 16, v85
    v_and_b32 v59, s23, v85
    v_lshlrev_b32 v60, 16, v86
    v_and_b32 v61, s23, v86
    v_lshlrev_b32 v62, 16, v87
    v_and_b32 v63, s23, v87
    v_lshlrev_b32 v64, 16, v88
    v_and_b32 v65, s23, v88
    v_lshlrev_b32 v66, 16, v89
    v_and_b32 v67, s23, v89
    v_lshlrev_b32 v68, 16, v90
    v_and_b32 v69, s23, v90
    v_lshlrev_b32 v70, 16, v91
    v_and_b32 v71, s23, v91
    v_pk_mul_f32 v[32:33], v[32:33], v[114:115] op_sel_hi:[1,0]
    v_pk_mul_f32 v[34:35], v[34:35], v[114:115] op_sel_hi:[1,0]
    v_pk_mul_f32 v[36:37], v[36:37], v[114:115] op_sel_hi:[1,0]
    v_pk_mul_f32 v[38:39], v[38:39], v[114:115] op_sel_hi:[1,0]
    v_cvt_pk_bf16_f32 v72, v32, v33
    v_cvt_pk_bf16_f32 v73, v34, v35
    v_cvt_pk_bf16_f32 v74, v36, v37
    v_cvt_pk_bf16_f32 v75, v38, v39
    buffer_store_dwordx4 v[72:75], v7, s[16:19], s21 offen sc1
    s_add_u32 s21, s21, 8192
    v_pk_mul_f32 v[40:41], v[40:41], v[114:115] op_sel_hi:[1,0]
    v_pk_mul_f32 v[42:43], v[42:43], v[114:115] op_sel_hi:[1,0]
    v_pk_mul_f32 v[44:45], v[44:45], v[114:115] op_sel_hi:[1,0]
    v_pk_mul_f32 v[46:47], v[46:47], v[114:115] op_sel_hi:[1,0]
    v_cvt_pk_bf16_f32 v76, v40, v41
    v_cvt_pk_bf16_f32 v77, v42, v43
    v_cvt_pk_bf16_f32 v78, v44, v45
    v_cvt_pk_bf16_f32 v79, v46, v47
    buffer_store_dwordx4 v[76:79], v7, s[16:19], s21 offen sc1
    s_add_u32 s21, s21, 8192
    v_pk_mul_f32 v[48:49], v[48:49], v[114:115] op_sel_hi:[1,0]
    v_pk_mul_f32 v[50:51], v[50:51], v[114:115] op_sel_hi:[1,0]
    v_pk_mul_f32 v[52:53], v[52:53], v[114:115] op_sel_hi:[1,0]
    v_pk_mul_f32 v[54:55], v[54:55], v[114:115] op_sel_hi:[1,0]
    v_cvt_pk_bf16_f32 v80, v48, v49
    v_cvt_pk_bf16_f32 v81, v50, v51
    v_cvt_pk_bf16_f32 v82, v52, v53
    v_cvt_pk_bf16_f32 v83, v54, v55
    buffer_store_dwordx4 v[80:83], v7, s[16:19], s21 offen sc1
    s_add_u32 s21, s21, 8192
    v_pk_mul_f32 v[56:57], v[56:57], v[114:115] op_sel_hi:[1,0]
    v_pk_mul_f32 v[58:59], v[58:59], v[114:115] op_sel_hi:[1,0]
    v_pk_mul_f32 v[60:61], v[60:61], v[114:115] op_sel_hi:[1,0]
    v_pk_mul_f32 v[62:63], v[62:63], v[114:115] op_sel_hi:[1,0]
    v_cvt_pk_bf16_f32 v84, v56, v57
    v_cvt_pk_bf16_f32 v85, v58, v59
    v_cvt_pk_bf16_f32 v86, v60, v61
    v_cvt_pk_bf16_f32 v87, v62, v63
    buffer_store_dwordx4 v[84:87], v7, s[16:19], s21 offen sc1
    s_add_u32 s21, s21, 8192
    v_pk_mul_f32 v[64:65], v[64:65], v[114:115] op_sel_hi:[1,0]
    v_pk_mul_f32 v[66:67], v[66:67], v[114:115] op_sel_hi:[1,0]
    v_pk_mul_f32 v[68:69], v[68:69], v[114:115] op_sel_hi:[1,0]
    v_pk_mul_f32 v[70:71], v[70:71], v[114:115] op_sel_hi:[1,0]
    v_cvt_pk_bf16_f32 v88, v64, v65
    v_cvt_pk_bf16_f32 v89, v66, v67
    v_cvt_pk_bf16_f32 v90, v68, v69
    v_cvt_pk_bf16_f32 v91, v70, v71
    buffer_store_dwordx4 v[88:91], v7, s[16:19], s21 offen sc1
    v_mov_b32 v228, v7
    s_add_u32 s55, s21, 24084480
    s_branch p0_drain
p0_w:
    s_cmp_ge_u32 s45, 248
    s_cbranch_scc1 p0_zero
    s_sub_u32 s21, s45, 128
    s_mul_i32 s30, s21, 171
    s_lshr_b32 s30, s30, 9
    s_mul_i32 s31, s30, 3
    s_sub_u32 s31, s21, s31
    s_mul_i32 s21, s30, 61440
    s_mul_i32 s22, s31, 1280
    s_add_u32 s21, s21, s22
    s_lshl_b32 s22, s20, 2
    s_mul_i32 s23, s20, 5120
    s_mov_b32 s10, 2457600
    s_mov_b32 s11, 0x20000
    v_add_u32 v4, 0, v1
    v_mul_u32_u24 v5, 205, v4
    v_lshrrev_b32 v5, 14, v5
    v_mul_u32_u24 v6, 80, v5
    v_sub_u32 v6, v4, v6
    v_lshlrev_b32 v6, 4, v6
    v_lshlrev_b32 v7, 6, v5
    v_add_u32 v5, s22, v5
    v_mul_u32_u24 v5, 3840, v5
    v_xad_u32 v12, v6, v7, v5
    v_add_u32 v4, 64, v1
    v_mul_u32_u24 v5, 205, v4
    v_lshrrev_b32 v5, 14, v5
    v_mul_u32_u24 v6, 80, v5
    v_sub_u32 v6, v4, v6
    v_lshlrev_b32 v6, 4, v6
    v_lshlrev_b32 v7, 6, v5
    v_add_u32 v5, s22, v5
    v_mul_u32_u24 v5, 3840, v5
    v_xad_u32 v13, v6, v7, v5
    v_add_u32 v4, 128, v1
    v_mul_u32_u24 v5, 205, v4
    v_lshrrev_b32 v5, 14, v5
    v_mul_u32_u24 v6, 80, v5
    v_sub_u32 v6, v4, v6
    v_lshlrev_b32 v6, 4, v6
    v_lshlrev_b32 v7, 6, v5
    v_add_u32 v5, s22, v5
    v_mul_u32_u24 v5, 3840, v5
    v_xad_u32 v14, v6, v7, v5
    v_add_u32 v4, 192, v1
    v_mul_u32_u24 v5, 205, v4
    v_lshrrev_b32 v5, 14, v5
    v_mul_u32_u24 v6, 80, v5
    v_sub_u32 v6, v4, v6
    v_lshlrev_b32 v6, 4, v6
    v_lshlrev_b32 v7, 6, v5
    v_add_u32 v5, s22, v5
    v_mul_u32_u24 v5, 3840, v5
    v_xad_u32 v15, v6, v7, v5
    v_add_u32 v4, 256, v1
    v_mul_u32_u24 v5, 205, v4
    v_lshrrev_b32 v5, 14, v5
    v_mul_u32_u24 v6, 80, v5
    v_sub_u32 v6, v4, v6
    v_lshlrev_b32 v6, 4, v6
    v_lshlrev_b32 v7, 6, v5
    v_add_u32 v5, s22, v5
    v_mul_u32_u24 v5, 3840, v5
    v_xad_u32 v16, v6, v7, v5
    s_waitcnt lgkmcnt(0)
    s_mov_b32 s8, s50
    s_mov_b32 s9, s51
    s_add_u32 m0, s23, 0
    s_nop 0
    buffer_load_dwordx4 v12, s[8:11], s21 offen nt lds
    s_add_u32 m0, s23, 1024
    s_nop 0
    buffer_load_dwordx4 v13, s[8:11], s21 offen nt lds
    s_add_u32 m0, s23, 2048
    s_nop 0
    buffer_load_dwordx4 v14, s[8:11], s21 offen nt lds
    s_add_u32 m0, s23, 3072
    s_nop 0
    buffer_load_dwordx4 v15, s[8:11], s21 offen nt lds
    s_add_u32 m0, s23, 4096
    s_nop 0
    buffer_load_dwordx4 v16, s[8:11], s21 offen nt lds
    s_load_dword s44, s[14:15], 0
    s_mov_b32 s16, s14
    s_mov_b32 s17, s15
    s_mov_b32 s18, 28311552
    s_mov_b32 s19, 0x20000
    v_lshrrev_b32 v30, 4, v1
    v_lshrrev_b32 v4, 1, v30
    v_lshl_add_u32 v4, v4, 3, v28
    v_mul_u32_u24 v4, 1280, v4
    v_and_b32 v5, 1, v30
    v_lshlrev_b32 v5, 5, v5
    v_lshl_add_u32 v5, v29, 3, v5
    v_lshlrev_b32 v6, 6, v28
    s_lshl_b32 s21, s30, 12
    s_add_u32 s21, s21, 3670016
    s_cmp_lg_u32 s31, 0
    s_cbranch_scc1 p0_wkv
    s_lshl_b32 s22, s20, 6
    v_add_u32 v5, s22, v5
    v_xad_u32 v7, v5, v6, v4
    s_lshl_b32 s22, s20, 10
    s_add_u32 s21, s21, s22
    s_add_u32 s21, s21, 1802240
    s_waitcnt vmcnt(0)
    s_barrier
    ds_read_b64_tr_b16 v[32:33], v7 offset:0
    ds_read_b64_tr_b16 v[34:35], v7 offset:5120
    ds_read_b64_tr_b16 v[36:37], v7 offset:256
    ds_read_b64_tr_b16 v[38:39], v7 offset:5376
    ds_read_b64_tr_b16 v[40:41], v7 offset:512
    ds_read_b64_tr_b16 v[42:43], v7 offset:5632
    ds_read_b64_tr_b16 v[44:45], v7 offset:768
    ds_read_b64_tr_b16 v[46:47], v7 offset:5888
    ds_read_b64_tr_b16 v[48:49], v7 offset:1024
    ds_read_b64_tr_b16 v[50:51], v7 offset:6144
    s_waitcnt lgkmcnt(8)
    buffer_store_dwordx4 v[32:35], v3, s[16:19], s21 offen sc1
    s_add_u32 s21, s21, 163840
    s_waitcnt lgkmcnt(6)
    buffer_store_dwordx4 v[36:39], v3, s[16:19], s21 offen sc1
    s_add_u32 s21, s21, 163840
    s_waitcnt lgkmcnt(4)
    buffer_store_dwordx4 v[40:43], v3, s[16:19], s21 offen sc1
    s_add_u32 s21, s21, 163840
    s_waitcnt lgkmcnt(2)
    buffer_store_dwordx4 v[44:47], v3, s[16:19], s21 offen sc1
    s_add_u32 s21, s21, 163840
    s_waitcnt lgkmcnt(0)
    buffer_store_dwordx4 v[48:51], v3, s[16:19], s21 offen sc1
    s_add_u32 s21, s21, 163840
    s_branch p0_drain
p0_wkv:
    s_and_b32 s22, s20, 1
    s_lshr_b32 s23, s20, 1
    s_lshl_b32 s24, s22, 6
    s_mul_i32 s25, s23, 120
    s_add_u32 s24, s24, s25
    v_add_u32 v5, s24, v5
    s_lshl_b32 s24, s31, 1
    s_add_u32 s24, s24, s22
    s_sub_u32 s24, s24, 2
    s_lshl_b32 s24, s24, 10
    s_add_u32 s21, s21, s24
    s_mul_i32 s24, s23, 163840
    s_add_u32 s21, s21, s24
    v_add_u32 v12, 0, v5
    v_min_u32 v12, 1272, v12
    v_xad_u32 v12, v12, v6, v4
    v_add_u32 v13, 240, v5
    v_min_u32 v13, 1272, v13
    v_xad_u32 v13, v13, v6, v4
    v_add_u32 v14, 480, v5
    v_min_u32 v14, 1272, v14
    v_xad_u32 v14, v14, v6, v4
    v_add_u32 v15, 720, v5
    v_min_u32 v15, 1272, v15
    v_xad_u32 v15, v15, v6, v4
    v_add_u32 v16, 960, v5
    v_min_u32 v16, 1272, v16
    v_xad_u32 v16, v16, v6, v4
    v_add_u32 v17, 1200, v5
    v_min_u32 v17, 1272, v17
    v_xad_u32 v17, v17, v6, v4
    s_waitcnt vmcnt(0)
    s_barrier
    ds_read_b64_tr_b16 v[32:33], v12
    ds_read_b64_tr_b16 v[34:35], v12 offset:5120
    ds_read_b64_tr_b16 v[36:37], v13
    ds_read_b64_tr_b16 v[38:39], v13 offset:5120
    ds_read_b64_tr_b16 v[40:41], v14
    ds_read_b64_tr_b16 v[42:43], v14 offset:5120
    ds_read_b64_tr_b16 v[44:45], v15
    ds_read_b64_tr_b16 v[46:47], v15 offset:5120
    ds_read_b64_tr_b16 v[48:49], v16
    ds_read_b64_tr_b16 v[50:51], v16 offset:5120
    ds_read_b64_tr_b16 v[52:53], v17
    ds_read_b64_tr_b16 v[54:55], v17 offset:5120
    s_waitcnt lgkmcnt(10)
    buffer_store_dwordx4 v[32:35], v3, s[16:19], s21 offen sc1
    s_add_u32 s21, s21, 327680
    s_waitcnt lgkmcnt(8)
    buffer_store_dwordx4 v[36:39], v3, s[16:19], s21 offen sc1
    s_add_u32 s21, s21, 327680
    s_waitcnt lgkmcnt(6)
    buffer_store_dwordx4 v[40:43], v3, s[16:19], s21 offen sc1
    s_add_u32 s21, s21, 327680
    s_waitcnt lgkmcnt(4)
    buffer_store_dwordx4 v[44:47], v3, s[16:19], s21 offen sc1
    s_add_u32 s21, s21, 327680
    s_waitcnt lgkmcnt(2)
    buffer_store_dwordx4 v[48:51], v3, s[16:19], s21 offen sc1
    s_add_u32 s21, s21, 327680
    s_cmp_lg_u32 s23, 0
    s_cbranch_scc1 p0_drain
    s_waitcnt lgkmcnt(0)
    buffer_store_dwordx4 v[52:55], v3, s[16:19], s21 offen sc1
    s_add_u32 s21, s21, 327680
    s_branch p0_drain
p0_zero:
    s_sub_u32 s21, s45, 248
    s_mul_i32 s21, s21, 6720
    s_add_u32 s21, s21, 131072
    v_lshlrev_b32 v4, 4, v0
    v_mov_b32 v8, 0
    v_mov_b32 v9, 0
    v_mov_b32 v10, 0
    v_mov_b32 v11, 0
    v_lshrrev_b32 v30, 4, v1
    s_mov_b32 s10, 6720
    s_mov_b32 s11, 0x20000
    s_waitcnt lgkmcnt(0)
    s_add_u32 s8, s14, s21
    s_addc_u32 s9, s15, 0
    buffer_store_dwordx4 v[8:11], v4, s[8:11], 0 offen sc1
    v_add_u32 v4, 4096, v4
    buffer_store_dwordx4 v[8:11], v4, s[8:11], 0 offen sc1
    s_load_dword s44, s[14:15], 0
    s_mov_b32 s16, s14
    s_mov_b32 s17, s15
    s_mov_b32 s18, 28311552
    s_mov_b32 s19, 0x20000
p0_drain:
    s_waitcnt vmcnt(0) lgkmcnt(0)
    s_add_u32 s44, s44, 1
    s_or_b32 s44, s44, 0x80000000
    s_barrier
    s_cmp_lg_u32 s20, 1
    s_cbranch_scc1 sig1
    v_lshlrev_b32 v5, 12, v1
    s_lshr_b32 s42, s45, 3
    s_lshl_b32 s42, s42, 7
    s_and_b32 s43, s45, 7
    s_lshl_b32 s43, s43, 2
    s_add_u32 s42, s42, s43
    s_add_u32 s42, s42, 524288
    v_mov_b32 v4, s44
    s_mov_b64 exec, 255
    buffer_store_dword v4, v5, s[16:19], s42 offen sc1
    s_mov_b64 exec, -1
sig1:
    s_cmp_lg_u32 s20, 2
    s_cbranch_scc1 p0_nob
    v_lshlrev_b32 v4, 7, v1
    v_min_u32 v5, 3068, v4
    v_min_u32 v4, 1276, v4
    global_load_dword v31, v5, s[58:59]
    global_load_dword v31, v4, s[62:63]
p0_nob:
    s_cmp_ge_u32 s45, 232
    s_cbranch_scc1 p0_uid
    s_sub_u32 s6, s20, 1
    s_mul_i32 s5, s6, 7168
    s_cmp_ge_u32 s45, 136
    s_cbranch_scc1 p0_ui_w2
    s_cmp_ge_u32 s45, 40
    s_cbranch_scc1 p0_ui_w1
    s_mov_b32 s8, s52
    s_mov_b32 s9, s53
    s_mov_b32 s10, 819200
    s_mov_b32 s11, 0x20000
    s_mul_i32 s35, s45, 26
    s_lshr_b32 s35, s35, 8
    s_mul_i32 s36, s35, 10
    s_sub_u32 s36, s45, s36
    s_mul_i32 s4, s35, 204800
    s_movk_i32 s25, 1280
    s_branch p0_ui_128
p0_ui_w1:
    s_mov_b32 s8, s56
    s_mov_b32 s9, s57
    s_mov_b32 s10, 1966080
    s_mov_b32 s11, 0x20000
    s_sub_u32 s34, s45, 40
    s_mul_i32 s35, s34, 43
    s_lshr_b32 s35, s35, 10
    s_mul_i32 s36, s35, 24
    s_sub_u32 s36, s34, s36
    s_mul_i32 s4, s35, 491520
    s_movk_i32 s25, 3072
p0_ui_128:
    s_cmp_eq_u32 s20, 0
    s_cbranch_scc1 p0_uid
    s_lshl_b32 s7, s36, 7
    s_add_u32 s4, s4, s7
    v_lshrrev_b32 v52, 3, v1
    s_mul_i32 s7, s6, 56
    v_add_u32 v52, s7, v52
    v_and_b32 v53, 7, v1
    v_lshlrev_b32 v53, 4, v53
    v_and_b32 v54, 2, v52
    v_lshlrev_b32 v54, 5, v54
    v_mul_lo_u32 v52, v52, s25
    v_xad_u32 v52, v53, v54, v52
    s_lshl_b32 s25, s25, 3
    s_add_u32 m0, s5, 131072
    s_nop 0
    buffer_load_dwordx4 v52, s[8:11], s4 offen nt lds
    s_add_u32 s4, s4, s25
    s_add_u32 m0, s5, 132096
    s_nop 0
    buffer_load_dwordx4 v52, s[8:11], s4 offen nt lds
    s_add_u32 s4, s4, s25
    s_add_u32 m0, s5, 133120
    s_nop 0
    buffer_load_dwordx4 v52, s[8:11], s4 offen nt lds
    s_add_u32 s4, s4, s25
    s_add_u32 m0, s5, 134144
    s_nop 0
    buffer_load_dwordx4 v52, s[8:11], s4 offen nt lds
    s_add_u32 s4, s4, s25
    s_add_u32 m0, s5, 135168
    s_nop 0
    buffer_load_dwordx4 v52, s[8:11], s4 offen nt lds
    s_add_u32 s4, s4, s25
    s_add_u32 m0, s5, 136192
    s_nop 0
    buffer_load_dwordx4 v52, s[8:11], s4 offen nt lds
    s_add_u32 s4, s4, s25
    s_add_u32 m0, s5, 137216
    s_nop 0
    buffer_load_dwordx4 v52, s[8:11], s4 offen nt lds
    s_add_u32 s4, s4, s25
    s_branch p0_uid
p0_ui_w2:
    s_mov_b32 s8, s60
    s_mov_b32 s9, s61
    s_mov_b32 s10, 1966080
    s_mov_b32 s11, 0x20000
    s_sub_u32 s34, s45, 136
    s_lshr_b32 s35, s34, 1
    s_and_b32 s36, s34, 1
    s_cmp_eq_u32 s20, 0
    s_cbranch_scc1 p0_uid
    s_mul_i32 s4, s35, 40960
    s_mul_i32 s7, s36, 640
    s_add_u32 s4, s4, s7
    s_mul_i32 s7, s6, 448
    v_add_u32 v56, s7, v1
    v_add_u32 v52, 0, v56
    v_mul_u32_u24 v53, 1639, v52
    v_lshrrev_b32 v53, 16, v53
    v_mul_u32_u24 v54, 40, v53
    v_sub_u32 v54, v52, v54
    v_lshlrev_b32 v54, 4, v54
    v_and_b32 v55, 2, v53
    v_lshlrev_b32 v55, 4, v55
    v_and_b32 v57, 16, v53
    v_lshl_or_b32 v55, v57, 2, v55
    v_mul_u32_u24 v53, 1280, v53
    v_xad_u32 v52, v54, v55, v53
    s_add_u32 m0, s5, 131072
    s_nop 0
    buffer_load_dwordx4 v52, s[8:11], s4 offen nt lds
    v_add_u32 v52, 64, v56
    v_mul_u32_u24 v53, 1639, v52
    v_lshrrev_b32 v53, 16, v53
    v_mul_u32_u24 v54, 40, v53
    v_sub_u32 v54, v52, v54
    v_lshlrev_b32 v54, 4, v54
    v_and_b32 v55, 2, v53
    v_lshlrev_b32 v55, 4, v55
    v_and_b32 v57, 16, v53
    v_lshl_or_b32 v55, v57, 2, v55
    v_mul_u32_u24 v53, 1280, v53
    v_xad_u32 v52, v54, v55, v53
    s_add_u32 m0, s5, 132096
    s_nop 0
    buffer_load_dwordx4 v52, s[8:11], s4 offen nt lds
    v_add_u32 v52, 128, v56
    v_mul_u32_u24 v53, 1639, v52
    v_lshrrev_b32 v53, 16, v53
    v_mul_u32_u24 v54, 40, v53
    v_sub_u32 v54, v52, v54
    v_lshlrev_b32 v54, 4, v54
    v_and_b32 v55, 2, v53
    v_lshlrev_b32 v55, 4, v55
    v_and_b32 v57, 16, v53
    v_lshl_or_b32 v55, v57, 2, v55
    v_mul_u32_u24 v53, 1280, v53
    v_xad_u32 v52, v54, v55, v53
    s_add_u32 m0, s5, 133120
    s_nop 0
    buffer_load_dwordx4 v52, s[8:11], s4 offen nt lds
    v_add_u32 v52, 192, v56
    v_mul_u32_u24 v53, 1639, v52
    v_lshrrev_b32 v53, 16, v53
    v_mul_u32_u24 v54, 40, v53
    v_sub_u32 v54, v52, v54
    v_lshlrev_b32 v54, 4, v54
    v_and_b32 v55, 2, v53
    v_lshlrev_b32 v55, 4, v55
    v_and_b32 v57, 16, v53
    v_lshl_or_b32 v55, v57, 2, v55
    v_mul_u32_u24 v53, 1280, v53
    v_xad_u32 v52, v54, v55, v53
    s_add_u32 m0, s5, 134144
    s_nop 0
    buffer_load_dwordx4 v52, s[8:11], s4 offen nt lds
    v_add_u32 v52, 256, v56
    v_mul_u32_u24 v53, 1639, v52
    v_lshrrev_b32 v53, 16, v53
    v_mul_u32_u24 v54, 40, v53
    v_sub_u32 v54, v52, v54
    v_lshlrev_b32 v54, 4, v54
    v_and_b32 v55, 2, v53
    v_lshlrev_b32 v55, 4, v55
    v_and_b32 v57, 16, v53
    v_lshl_or_b32 v55, v57, 2, v55
    v_mul_u32_u24 v53, 1280, v53
    v_xad_u32 v52, v54, v55, v53
    s_add_u32 m0, s5, 135168
    s_nop 0
    buffer_load_dwordx4 v52, s[8:11], s4 offen nt lds
    v_add_u32 v52, 320, v56
    v_mul_u32_u24 v53, 1639, v52
    v_lshrrev_b32 v53, 16, v53
    v_mul_u32_u24 v54, 40, v53
    v_sub_u32 v54, v52, v54
    v_lshlrev_b32 v54, 4, v54
    v_and_b32 v55, 2, v53
    v_lshlrev_b32 v55, 4, v55
    v_and_b32 v57, 16, v53
    v_lshl_or_b32 v55, v57, 2, v55
    v_mul_u32_u24 v53, 1280, v53
    v_xad_u32 v52, v54, v55, v53
    s_add_u32 m0, s5, 136192
    s_nop 0
    buffer_load_dwordx4 v52, s[8:11], s4 offen nt lds
    v_add_u32 v52, 384, v56
    v_mul_u32_u24 v53, 1639, v52
    v_lshrrev_b32 v53, 16, v53
    v_mul_u32_u24 v54, 40, v53
    v_sub_u32 v54, v52, v54
    v_lshlrev_b32 v54, 4, v54
    v_and_b32 v55, 2, v53
    v_lshlrev_b32 v55, 4, v55
    v_and_b32 v57, 16, v53
    v_lshl_or_b32 v55, v57, 2, v55
    v_mul_u32_u24 v53, 1280, v53
    v_xad_u32 v52, v54, v55, v53
    s_add_u32 m0, s5, 137216
    s_nop 0
    buffer_load_dwordx4 v52, s[8:11], s4 offen nt lds
p0_uid:
    v_add_u32 v4, 0x10000, v3
    v_add_u32 v5, 0x20000, v3
    s_lshl_b32 s28, s26, 2
    s_add_u32 s28, s28, s20
    s_mul_i32 s21, s28, 40960
    s_add_u32 s21, s21, 1048576
    s_lshl_b32 s23, s20, 12
    s_mul_i32 s22, s27, 163840
    s_add_u32 s22, s22, s23
    s_add_u32 s22, s22, 3670016
    s_mov_b32 s40, 0x3fb8aa3b
    s_mov_b32 s41, 0x3fb8aa3b
    s_mov_b32 s38, 0x358637bd
    s_mov_b32 s39, 0x358637bd
    s_mov_b32 s50, s26
    s_mov_b32 s51, s27
    s_lshr_b32 s33, s27, 3
    s_lshl_b32 s13, s33, 2
    s_and_b32 s12, s27, 3
    s_add_u32 s13, s13, s12
    s_bfe_u32 s12, s27, 0x10002
    s_lshl_b32 s31, s26, 1
    s_add_u32 s12, s12, s31
    s_lshl_b32 s31, s26, 2
    s_bfe_u32 s29, s27, 0x20001
    s_add_u32 s29, s29, s31
    s_lshl_b32 s30, s33, 1
    s_and_b32 s33, s27, 1
    s_add_u32 s30, s30, s33
    s_lshl_b32 s31, s30, 2
    s_add_u32 s31, s31, s20
    s_mul_i32 s31, s31, 51200
    s_add_u32 s31, s31, 6291456
    v_and_b32 v24, 31, v1
    s_lshl_b32 s33, s29, 5
    v_add_u32 v24, s33, v24
    v_mul_u32_u24 v24, 1280, v24
    v_lshrrev_b32 v25, 5, v1
    v_lshl_add_u32 v24, v25, 3, v24
    s_mul_i32 s3, s30, 320
    s_lshl_b32 s34, s20, 4
    s_add_u32 s3, s3, s34
    v_lshlrev_b32 v26, 2, v0
    v_lshlrev_b32 v27, 1, v0
    s_mul_i32 s33, s51, 192
    s_add_u32 s58, s58, s33
    s_addc_u32 s59, s59, 0
    s_mul_i32 s54, s51, 384
    s_add_u32 s54, s54, 65536
    s_lshl_b32 s33, s20, 13
    s_add_u32 s33, s33, 32768
    v_add_u32 v240, s33, v3
    s_lshr_b32 s33, s20, 1
    s_and_b32 s34, s20, 1
    s_lshl_b32 s4, s33, 11
    s_add_u32 s4, s4, 32768
    v_add_u32 v236, s4, v3
    s_lshl_b32 s4, s34, 11
    s_add_u32 s4, s4, 36864
    v_add_u32 v237, s4, v3
    v_and_b32 v10, 31, v1
    s_lshl_b32 s4, s34, 5
    v_add_u32 v10, s4, v10
    v_mul_u32_u24 v11, 205, v10
    v_lshrrev_b32 v11, 12, v11
    v_mul_u32_u24 v12, 20, v11
    v_sub_u32 v12, v10, v12
    v_cmp_eq_u32 s[6:7], 60, v10
    v_mov_b32 v13, 20
    v_lshrrev_b32 v14, 5, v1
    v_cndmask_b32 v12, v12, v13, s[6:7]
    v_mul_u32_u24 v12, 80, v12
    v_lshlrev_b32 v14, 2, v14
    s_lshl_b32 s4, s33, 5
    v_add_u32 v14, s4, v14
    v_lshlrev_b32 v238, 2, v0
    v_add_u32 v239, 65536, v238
    v_add_u32 v12, 65536, v12
    v_add_u32 v15, 0, v14
    v_mul_u32_u24 v20, 205, v15
    v_lshrrev_b32 v20, 12, v20
    v_mul_u32_u24 v21, 20, v20
    v_sub_u32 v21, v15, v21
    v_cmp_eq_u32 s[92:93], v20, v11
    v_cmp_gt_u32 vcc, 3, v20
    v_mul_u32_u24 v20, 1680, v20
    v_lshl_add_u32 v21, v21, 2, v12
    v_add_u32 v232, v20, v21
    s_or_b64 s[92:93], s[92:93], s[6:7]
    s_and_b64 s[92:93], s[92:93], vcc
    v_add_u32 v15, 8, v14
    v_mul_u32_u24 v20, 205, v15
    v_lshrrev_b32 v20, 12, v20
    v_mul_u32_u24 v21, 20, v20
    v_sub_u32 v21, v15, v21
    v_cmp_eq_u32 s[94:95], v20, v11
    v_cmp_gt_u32 vcc, 3, v20
    v_mul_u32_u24 v20, 1680, v20
    v_lshl_add_u32 v21, v21, 2, v12
    v_add_u32 v233, v20, v21
    s_or_b64 s[94:95], s[94:95], s[6:7]
    s_and_b64 s[94:95], s[94:95], vcc
    v_add_u32 v15, 16, v14
    v_mul_u32_u24 v20, 205, v15
    v_lshrrev_b32 v20, 12, v20
    v_mul_u32_u24 v21, 20, v20
    v_sub_u32 v21, v15, v21
    v_cmp_eq_u32 s[96:97], v20, v11
    v_cmp_gt_u32 vcc, 3, v20
    v_mul_u32_u24 v20, 1680, v20
    v_lshl_add_u32 v21, v21, 2, v12
    v_add_u32 v234, v20, v21
    s_or_b64 s[96:97], s[96:97], s[6:7]
    s_and_b64 s[96:97], s[96:97], vcc
    v_add_u32 v15, 24, v14
    v_mul_u32_u24 v20, 205, v15
    v_lshrrev_b32 v20, 12, v20
    v_mul_u32_u24 v21, 20, v20
    v_sub_u32 v21, v15, v21
    v_cmp_eq_u32 s[98:99], v20, v11
    v_cmp_gt_u32 vcc, 3, v20
    v_mul_u32_u24 v20, 1680, v20
    v_lshl_add_u32 v21, v21, 2, v12
    v_add_u32 v235, v20, v21
    s_or_b64 s[98:99], s[98:99], s[6:7]
    s_and_b64 s[98:99], s[98:99], vcc
    s_mov_b32 s8, s14
    s_mov_b32 s9, s15
    s_mov_b32 s10, 0
    s_mov_b32 s11, 0x20000
    v_mov_b32 v62, 0x7ffffff0
    s_mov_b32 s37, 0
    s_mov_b32 s24, 0
    s_mov_b32 s25, 0
    v_mov_b32 v52, 131072
    v_mov_b32 v53, 131072
    v_mov_b32 v54, 131072
    v_mov_b32 v55, 131072
    v_mov_b32 v56, 131072
    v_mov_b32 v57, 131072
    v_mov_b32 v58, 131072
    v_mov_b32 v59, 131072
    v_mov_b32 v60, 131072
    v_mov_b32 v61, 131072
    s_cmp_lt_u32 s45, 40
    s_cbranch_scc1 upp_end
    s_cmp_ge_u32 s45, 232
    s_cbranch_scc1 upp_end
    s_mov_b32 s10, 28311552
    s_cmp_ge_u32 s45, 136
    s_cbranch_scc1 upp_w2
    s_and_b32 s6, s20, 1
    s_lshr_b32 s7, s20, 1
    s_lshl_b32 s37, s36, 1
    s_add_u32 s37, s37, s6
    v_lshrrev_b32 v52, 1, v30
    v_lshl_add_u32 v52, v52, 3, v28
    v_and_b32 v53, 1, v30
    v_lshlrev_b32 v53, 5, v53
    v_lshl_add_u32 v53, v29, 3, v53
    s_lshl_b32 s24, s6, 6
    v_add_u32 v53, s24, v53
    v_and_b32 v54, 2, v28
    v_lshlrev_b32 v54, 5, v54
    v_lshlrev_b32 v52, 7, v52
    v_xad_u32 v52, v53, v54, v52
    s_mul_i32 s24, s7, 10240
    s_add_u32 s24, s24, 131072
    v_add_u32 v52, s24, v52
    s_mul_i32 s24, s37, 171
    s_lshr_b32 s24, s24, 9
    s_mul_i32 s25, s24, 3
    s_sub_u32 s25, s37, s25
    s_mul_i32 s24, s24, 40
    s_mul_i32 s5, s35, 10
    s_add_u32 s24, s24, s5
    s_mul_i32 s5, s7, 5
    s_add_u32 s24, s24, s5
    s_mul_i32 s24, s24, 3
    s_add_u32 s24, s24, s25
    s_lshl_b32 s24, s24, 10
    s_add_u32 s24, s24, 7340032
    s_movk_i32 s25, 3072
    s_lshl_b32 s5, s35, 1
    s_add_u32 s5, s5, s7
    s_mul_i32 s5, s5, 6144
    s_lshl_b32 s37, s37, 7
    s_add_u32 s37, s37, s5
    s_add_u32 s37, s37, 65536
    v_lshlrev_b32 v53, 2, v1
    v_cmp_gt_u32 vcc, 32, v1
    s_nop 1
    v_cndmask_b32 v62, v62, v53, vcc
    v_add_u32 v53, 2048, v52
    v_add_u32 v54, 4096, v52
    v_add_u32 v55, 6144, v52
    v_add_u32 v56, 8192, v52
    v_add_u32 v57, 512, v52
    v_add_u32 v58, 512, v53
    v_add_u32 v59, 512, v54
    v_add_u32 v60, 512, v55
    v_add_u32 v61, 512, v56
    s_branch upp_end
upp_w2:
    v_and_b32 v57, 1, v30
    v_lshlrev_b32 v57, 4, v57
    v_lshrrev_b32 v58, 1, v30
    v_lshl_add_u32 v57, v58, 2, v57
    v_add_u32 v57, v57, v28
    v_and_b32 v59, 2, v57
    v_lshlrev_b32 v59, 4, v59
    v_and_b32 v60, 16, v57
    v_lshl_or_b32 v59, v60, 2, v59
    v_mul_u32_u24 v57, 640, v57
    v_add_u32 v57, 131072, v57
    s_mul_i32 s24, s20, 160
    v_lshl_add_u32 v58, v29, 3, s24
    s_lshl_b32 s24, s36, 2
    s_add_u32 s24, s24, s20
    s_mul_i32 s24, s24, 48
    s_add_u32 s24, s24, s35
    s_mul_i32 s24, s24, 5120
    s_add_u32 s24, s24, 9437184
    s_movk_i32 s25, 1024
    v_add_u32 v60, 0, v58
    v_xad_u32 v52, v60, v59, v57
    v_add_u32 v60, 32, v58
    v_xad_u32 v53, v60, v59, v57
    v_add_u32 v60, 64, v58
    v_xad_u32 v54, v60, v59, v57
    v_add_u32 v60, 96, v58
    v_xad_u32 v55, v60, v59, v57
    v_add_u32 v60, 128, v58
    v_xad_u32 v56, v60, v59, v57
    v_add_u32 v57, 5120, v52
    v_add_u32 v58, 5120, v53
    v_add_u32 v59, 5120, v54
    v_add_u32 v60, 5120, v55
    v_add_u32 v61, 5120, v56
upp_end:
    s_mul_i32 s33, s20, 192
    s_lshl_b32 s34, s29, 5
    s_mul_i32 s4, s30, 320
    s_mul_i32 s55, s20, 3072
    v_add_u32 v16, s33, v1
    v_add_u32 v16, 0, v16
    v_mul_u32_u24 v17, 205, v16
    v_lshrrev_b32 v17, 12, v17
    v_mul_u32_u24 v18, 20, v17
    v_sub_u32 v18, v16, v18
    v_min_u32 v17, 31, v17
    v_add_u32 v17, s34, v17
    v_mul_u32_u24 v17, 1280, v17
    v_lshl_add_u32 v16, v18, 4, v17
    v_add_u32 v229, s4, v16
    v_add_u32 v16, s33, v1
    v_add_u32 v16, 64, v16
    v_mul_u32_u24 v17, 205, v16
    v_lshrrev_b32 v17, 12, v17
    v_mul_u32_u24 v18, 20, v17
    v_sub_u32 v18, v16, v18
    v_min_u32 v17, 31, v17
    v_add_u32 v17, s34, v17
    v_mul_u32_u24 v17, 1280, v17
    v_lshl_add_u32 v16, v18, 4, v17
    v_add_u32 v230, s4, v16
    v_add_u32 v16, s33, v1
    v_add_u32 v16, 128, v16
    v_mul_u32_u24 v17, 205, v16
    v_lshrrev_b32 v17, 12, v17
    v_mul_u32_u24 v18, 20, v17
    v_sub_u32 v18, v16, v18
    v_min_u32 v17, 31, v17
    v_add_u32 v17, s34, v17
    v_mul_u32_u24 v17, 1280, v17
    v_lshl_add_u32 v16, v18, 4, v17
    v_add_u32 v231, s4, v16
    v_add_u32 v24, s3, v24
    v_min_u32 v27, 190, v27
    s_and_b32 s42, s2, 7
    s_lshl_b32 s42, s42, 12
    s_add_u32 s42, s42, 524288
    v_lshrrev_b32 v12, 1, v1
    v_lshlrev_b32 v12, 7, v12
    v_and_b32 v8, 1, v1
    v_lshl_add_u32 v12, v8, 4, v12
    s_cmp_lg_u32 s20, 0
    s_cbranch_scc1 poll1d
    s_sleep 20
    s_mov_b32 s43, 0x20000
poll1:
    buffer_load_dwordx4 v[8:11], v12, s[16:19], s42 offen sc1
    s_waitcnt vmcnt(0)
    v_xor_b32 v8, s44, v8
    v_xor_b32 v9, s44, v9
    v_xor_b32 v10, s44, v10
    v_xor_b32 v11, s44, v11
    v_or3_b32 v8, v8, v9, v10
    v_or_b32 v8, v8, v11
    v_cmp_ne_u32 vcc, 0, v8
    s_cbranch_vccz poll1d
    s_sleep 8
    s_sub_u32 s43, s43, 1
    s_cbranch_scc0 poll1
poll1d:
    s_barrier
    s_add_u32 m0, s23, 0
    s_nop 0
    buffer_load_dwordx4 v3, s[16:19], s22 offen offset:0 sc1 lds
    buffer_load_dwordx4 v3, s[16:19], s22 offen offset:1024 sc1 lds
    buffer_load_dwordx4 v3, s[16:19], s22 offen offset:2048 sc1 lds
    buffer_load_dwordx4 v3, s[16:19], s22 offen offset:3072 sc1 lds
    s_add_u32 s22, s22, 16384
    buffer_load_dwordx4 a[0:3], v3, s[16:19], s21 offen offset:0 sc1
    buffer_load_dwordx4 a[4:7], v3, s[16:19], s21 offen offset:1024 sc1
    buffer_load_dwordx4 a[8:11], v3, s[16:19], s21 offen offset:2048 sc1
    buffer_load_dwordx4 a[12:15], v3, s[16:19], s21 offen offset:3072 sc1
    s_add_u32 s21, s21, 4096
    s_add_u32 m0, s23, 16384
    s_nop 0
    buffer_load_dwordx4 v3, s[16:19], s22 offen offset:0 sc1 lds
    buffer_load_dwordx4 v3, s[16:19], s22 offen offset:1024 sc1 lds
    buffer_load_dwordx4 v3, s[16:19], s22 offen offset:2048 sc1 lds
    buffer_load_dwordx4 v3, s[16:19], s22 offen offset:3072 sc1 lds
    s_add_u32 s22, s22, 16384
    buffer_load_dwordx4 a[16:19], v3, s[16:19], s21 offen offset:0 sc1
    buffer_load_dwordx4 a[20:23], v3, s[16:19], s21 offen offset:1024 sc1
    buffer_load_dwordx4 a[24:27], v3, s[16:19], s21 offen offset:2048 sc1
    buffer_load_dwordx4 a[28:31], v3, s[16:19], s21 offen offset:3072 sc1
    s_add_u32 s21, s21, 4096
    s_waitcnt vmcnt(12)
    s_barrier
    s_cmp_ge_u32 s45, 40
    s_cbranch_scc1 up_end
    s_cmp_ge_u32 s45, 136
    s_cbranch_scc1 up_w2
    s_and_b32 s6, s20, 1
    s_lshr_b32 s7, s20, 1
    s_lshl_b32 s37, s36, 1
    s_add_u32 s37, s37, s6
    s_cmp_ge_u32 s45, 40
    s_cbranch_scc1 up_w1
    v_and_b32 v52, 1, v30
    v_lshrrev_b32 v53, 1, v29
    v_lshl_add_u32 v52, v52, 1, v53
    v_add_u32 v52, s35, v52
    v_and_b32 v52, 3, v52
    v_lshlrev_b32 v52, 4, v52
    v_and_b32 v53, 1, v29
    v_lshl_add_u32 v52, v53, 3, v52
    s_lshl_b32 s24, s6, 6
    v_add_u32 v52, s24, v52
    v_and_b32 v53, 2, v28
    v_lshlrev_b32 v53, 5, v53
    v_xor_b32 v52, v52, v53
    v_lshl_add_u32 v52, v28, 7, v52
    s_mul_i32 s24, s7, 10240
    s_add_u32 s24, s24, 131072
    v_add_u32 v52, s24, v52
    v_lshrrev_b32 v54, 5, v1
    v_lshlrev_b32 v54, 4, v54
    s_mul_i32 s24, s37, 205
    s_lshr_b32 s24, s24, 10
    s_mul_i32 s25, s24, 5
    s_sub_u32 s25, s37, s25
    s_lshl_b32 s24, s24, 2
    s_add_u32 s24, s24, s35
    s_mul_i32 s24, s24, 10
    s_mul_i32 s4, s7, 5
    s_add_u32 s24, s24, s4
    s_mul_i32 s24, s24, 5
    s_add_u32 s24, s24, s25
    s_lshl_b32 s24, s24, 10
    s_add_u32 s24, s24, 6291456
    s_mov_b32 s25, 0x6000000
    v_bfe_u32 v55, s25, v54, 16
    v_add_u32 v55, v55, v52
    ds_read_b64_tr_b16 v[32:33], v55
    s_mov_b32 s25, 0x8000200
    v_bfe_u32 v55, s25, v54, 16
    v_add_u32 v55, v55, v52
    ds_read_b64_tr_b16 v[34:35], v55
    s_mov_b32 s25, 0xe000a00
    v_bfe_u32 v55, s25, v54, 16
    v_add_u32 v55, v55, v52
    ds_read_b64_tr_b16 v[36:37], v55
    s_mov_b32 s25, 0x10000c00
    v_bfe_u32 v55, s25, v54, 16
    v_add_u32 v55, v55, v52
    ds_read_b64_tr_b16 v[38:39], v55
    s_mov_b32 s25, 0x12000400
    v_bfe_u32 v55, s25, v54, 16
    v_add_u32 v55, v55, v52
    ds_read_b64_tr_b16 v[40:41], v55
    s_mov_b32 s25, 0x1a001400
    v_bfe_u32 v55, s25, v54, 16
    v_add_u32 v55, v55, v52
    ds_read_b64_tr_b16 v[42:43], v55
    s_mov_b32 s25, 0x1c001600
    v_bfe_u32 v55, s25, v54, 16
    v_add_u32 v55, v55, v52
    ds_read_b64_tr_b16 v[44:45], v55
    s_mov_b32 s25, 0x22001e00
    v_bfe_u32 v55, s25, v54, 16
    v_add_u32 v55, v55, v52
    ds_read_b64_tr_b16 v[46:47], v55
    s_mov_b32 s25, 0x24002000
    v_bfe_u32 v55, s25, v54, 16
    v_add_u32 v55, v55, v52
    ds_read_b64_tr_b16 v[48:49], v55
    s_mov_b32 s25, 0x26001800
    v_bfe_u32 v55, s25, v54, 16
    v_add_u32 v55, v55, v52
    ds_read_b64_tr_b16 v[50:51], v55
    s_waitcnt lgkmcnt(8)
    buffer_store_dwordx4 v[32:35], v3, s[16:19], s24 offen sc1
    s_add_u32 s24, s24, 5120
    s_waitcnt lgkmcnt(6)
    buffer_store_dwordx4 v[36:39], v3, s[16:19], s24 offen sc1
    s_add_u32 s24, s24, 5120
    s_waitcnt lgkmcnt(4)
    buffer_store_dwordx4 v[40:43], v3, s[16:19], s24 offen sc1
    s_add_u32 s24, s24, 5120
    s_waitcnt lgkmcnt(2)
    buffer_store_dwordx4 v[44:47], v3, s[16:19], s24 offen sc1
    s_add_u32 s24, s24, 5120
    s_waitcnt lgkmcnt(0)
    buffer_store_dwordx4 v[48:51], v3, s[16:19], s24 offen sc1
    s_add_u32 s24, s24, 5120
    s_branch up_end
up_w1:
    v_lshrrev_b32 v52, 1, v30
    v_lshl_add_u32 v52, v52, 3, v28
    v_and_b32 v53, 1, v30
    v_lshlrev_b32 v53, 5, v53
    v_lshl_add_u32 v53, v29, 3, v53
    s_lshl_b32 s24, s6, 6
    v_add_u32 v53, s24, v53
    v_and_b32 v54, 2, v28
    v_lshlrev_b32 v54, 5, v54
    v_lshlrev_b32 v52, 7, v52
    v_xad_u32 v52, v53, v54, v52
    s_mul_i32 s24, s7, 10240
    s_add_u32 s24, s24, 131072
    v_add_u32 v52, s24, v52
    v_mov_b32 v56, 0
    s_mov_b32 s4, 0x3f803f80
    s_mul_i32 s24, s37, 171
    s_lshr_b32 s24, s24, 9
    s_mul_i32 s25, s24, 3
    s_sub_u32 s25, s37, s25
    s_mul_i32 s24, s24, 40
    s_mul_i32 s5, s35, 10
    s_add_u32 s24, s24, s5
    s_mul_i32 s5, s7, 5
    s_add_u32 s24, s24, s5
    s_mul_i32 s24, s24, 3
    s_add_u32 s24, s24, s25
    s_lshl_b32 s24, s24, 10
    s_add_u32 s24, s24, 7340032
    ds_read_b64_tr_b16 v[32:33], v52 offset:0
    ds_read_b64_tr_b16 v[34:35], v52 offset:512
    ds_read_b64_tr_b16 v[36:37], v52 offset:2048
    ds_read_b64_tr_b16 v[38:39], v52 offset:2560
    ds_read_b64_tr_b16 v[40:41], v52 offset:4096
    ds_read_b64_tr_b16 v[42:43], v52 offset:4608
    ds_read_b64_tr_b16 v[44:45], v52 offset:6144
    ds_read_b64_tr_b16 v[46:47], v52 offset:6656
    ds_read_b64_tr_b16 v[48:49], v52 offset:8192
    ds_read_b64_tr_b16 v[50:51], v52 offset:8704
    s_waitcnt lgkmcnt(8)
    buffer_store_dwordx4 v[32:35], v3, s[16:19], s24 offen sc1
    s_add_u32 s24, s24, 3072
    v_dot2_f32_bf16 v56, v32, s4, v56
    v_dot2_f32_bf16 v56, v33, s4, v56
    v_dot2_f32_bf16 v56, v34, s4, v56
    v_dot2_f32_bf16 v56, v35, s4, v56
    s_waitcnt lgkmcnt(6)
    buffer_store_dwordx4 v[36:39], v3, s[16:19], s24 offen sc1
    s_add_u32 s24, s24, 3072
    v_dot2_f32_bf16 v56, v36, s4, v56
    v_dot2_f32_bf16 v56, v37, s4, v56
    v_dot2_f32_bf16 v56, v38, s4, v56
    v_dot2_f32_bf16 v56, v39, s4, v56
    s_waitcnt lgkmcnt(4)
    buffer_store_dwordx4 v[40:43], v3, s[16:19], s24 offen sc1
    s_add_u32 s24, s24, 3072
    v_dot2_f32_bf16 v56, v40, s4, v56
    v_dot2_f32_bf16 v56, v41, s4, v56
    v_dot2_f32_bf16 v56, v42, s4, v56
    v_dot2_f32_bf16 v56, v43, s4, v56
    s_waitcnt lgkmcnt(2)
    buffer_store_dwordx4 v[44:47], v3, s[16:19], s24 offen sc1
    s_add_u32 s24, s24, 3072
    v_dot2_f32_bf16 v56, v44, s4, v56
    v_dot2_f32_bf16 v56, v45, s4, v56
    v_dot2_f32_bf16 v56, v46, s4, v56
    v_dot2_f32_bf16 v56, v47, s4, v56
    s_waitcnt lgkmcnt(0)
    buffer_store_dwordx4 v[48:51], v3, s[16:19], s24 offen sc1
    s_add_u32 s24, s24, 3072
    v_dot2_f32_bf16 v56, v48, s4, v56
    v_dot2_f32_bf16 v56, v49, s4, v56
    v_dot2_f32_bf16 v56, v50, s4, v56
    v_dot2_f32_bf16 v56, v51, s4, v56
    s_nop 2
    v_mov_b32 v57, v56
    s_lshl_b32 s24, s35, 1
    s_add_u32 s24, s24, s7
    v_permlane32_swap_b32 v56, v57
    s_mul_i32 s24, s24, 6144
    s_lshl_b32 s25, s37, 7
    s_add_u32 s24, s24, s25
    s_add_u32 s24, s24, 65536
    v_add_f32 v56, v56, v57
    v_lshlrev_b32 v57, 2, v1
    s_mov_b64 exec, 0xffffffff
    buffer_store_dword v56, v57, s[16:19], s24 offen sc1
    s_mov_b64 exec, -1
    s_branch up_end
up_w2:
    v_and_b32 v52, 1, v30
    v_lshlrev_b32 v52, 4, v52
    v_lshrrev_b32 v53, 1, v30
    v_lshl_add_u32 v52, v53, 2, v52
    v_add_u32 v52, v52, v28
    v_and_b32 v54, 2, v52
    v_lshlrev_b32 v54, 4, v54
    v_and_b32 v55, 16, v52
    v_lshl_or_b32 v54, v55, 2, v54
    v_mul_u32_u24 v52, 640, v52
    v_add_u32 v52, 131072, v52
    s_mul_i32 s24, s20, 160
    v_lshl_add_u32 v53, v29, 3, s24
    s_lshl_b32 s24, s36, 2
    s_add_u32 s24, s24, s20
    s_mul_i32 s24, s24, 48
    s_add_u32 s24, s24, s35
    s_mul_i32 s24, s24, 5120
    s_add_u32 s24, s24, 9437184
    v_add_u32 v55, 0, v53
    v_xad_u32 v55, v55, v54, v52
    ds_read_b64_tr_b16 v[32:33], v55
    ds_read_b64_tr_b16 v[34:35], v55 offset:5120
    v_add_u32 v55, 32, v53
    v_xad_u32 v55, v55, v54, v52
    ds_read_b64_tr_b16 v[36:37], v55
    ds_read_b64_tr_b16 v[38:39], v55 offset:5120
    v_add_u32 v55, 64, v53
    v_xad_u32 v55, v55, v54, v52
    ds_read_b64_tr_b16 v[40:41], v55
    ds_read_b64_tr_b16 v[42:43], v55 offset:5120
    v_add_u32 v55, 96, v53
    v_xad_u32 v55, v55, v54, v52
    ds_read_b64_tr_b16 v[44:45], v55
    ds_read_b64_tr_b16 v[46:47], v55 offset:5120
    v_add_u32 v55, 128, v53
    v_xad_u32 v55, v55, v54, v52
    ds_read_b64_tr_b16 v[48:49], v55
    ds_read_b64_tr_b16 v[50:51], v55 offset:5120
    s_waitcnt lgkmcnt(8)
    buffer_store_dwordx4 v[32:35], v3, s[16:19], s24 offen sc1
    s_add_u32 s24, s24, 1024
    s_waitcnt lgkmcnt(6)
    buffer_store_dwordx4 v[36:39], v3, s[16:19], s24 offen sc1
    s_add_u32 s24, s24, 1024
    s_waitcnt lgkmcnt(4)
    buffer_store_dwordx4 v[40:43], v3, s[16:19], s24 offen sc1
    s_add_u32 s24, s24, 1024
    s_waitcnt lgkmcnt(2)
    buffer_store_dwordx4 v[44:47], v3, s[16:19], s24 offen sc1
    s_add_u32 s24, s24, 1024
    s_waitcnt lgkmcnt(0)
    buffer_store_dwordx4 v[48:51], v3, s[16:19], s24 offen sc1
    s_add_u32 s24, s24, 1024
up_end:
    s_cmp_ge_u32 s27, 11
    s_cbranch_scc1 p1_q
    ds_read_b128 v[128:131], v3 offset:0
    ds_read_b128 v[132:135], v3 offset:1024
    ds_read_b128 v[136:139], v3 offset:2048
    ds_read_b128 v[140:143], v3 offset:3072
    ds_read_b128 v[144:147], v3 offset:4096
    ds_read_b128 v[148:151], v3 offset:5120
    ds_read_b128 v[152:155], v3 offset:6144
    ds_read_b128 v[156:159], v3 offset:7168
    s_waitcnt vmcnt(11) lgkmcnt(4)
    v_mfma_f32_32x32x16_bf16 v[64:79], a[0:3], v[128:131], 0
    s_add_u32 m0, s23, 32768
    s_nop 0
    buffer_load_dwordx4 v3, s[16:19], s22 offen offset:0 sc1 lds
    v_mfma_f32_32x32x16_bf16 v[80:95], a[0:3], v[132:135], 0
    ds_read_b128 v[160:163], v3 offset:8192
    ds_read_b128 v[164:167], v3 offset:9216
    v_mfma_f32_32x32x16_bf16 v[96:111], a[0:3], v[136:139], 0
    buffer_load_dwordx4 v3, s[16:19], s22 offen offset:1024 sc1 lds
    v_mfma_f32_32x32x16_bf16 v[112:127], a[0:3], v[140:143], 0
    ds_read_b128 v[168:171], v3 offset:10240
    ds_read_b128 v[172:175], v3 offset:11264
    s_waitcnt vmcnt(12) lgkmcnt(4)
    v_mfma_f32_32x32x16_bf16 v[64:79], a[4:7], v[144:147], v[64:79]
    buffer_load_dwordx4 v3, s[16:19], s22 offen offset:2048 sc1 lds
    v_mfma_f32_32x32x16_bf16 v[80:95], a[4:7], v[148:151], v[80:95]
    ds_read_b128 v[128:131], v3 offset:12288
    ds_read_b128 v[132:135], v3 offset:13312
    v_mfma_f32_32x32x16_bf16 v[96:111], a[4:7], v[152:155], v[96:111]
    buffer_load_dwordx4 v3, s[16:19], s22 offen offset:3072 sc1 lds
    s_add_u32 s22, s22, 16384
    v_mfma_f32_32x32x16_bf16 v[112:127], a[4:7], v[156:159], v[112:127]
    ds_read_b128 v[136:139], v3 offset:14336
    ds_read_b128 v[140:143], v3 offset:15360
    s_waitcnt vmcnt(13) lgkmcnt(4)
    v_mfma_f32_32x32x16_bf16 v[64:79], a[8:11], v[160:163], v[64:79]
    buffer_load_dwordx4 a[32:35], v3, s[16:19], s21 offen offset:0 sc1
    v_mfma_f32_32x32x16_bf16 v[80:95], a[8:11], v[164:167], v[80:95]
    s_waitcnt vmcnt(9)
    s_barrier
    ds_read_b128 v[144:147], v3 offset:16384
    ds_read_b128 v[148:151], v3 offset:17408
    v_mfma_f32_32x32x16_bf16 v[96:111], a[8:11], v[168:171], v[96:111]
    buffer_load_dwordx4 a[36:39], v3, s[16:19], s21 offen offset:1024 sc1
    v_mfma_f32_32x32x16_bf16 v[112:127], a[8:11], v[172:175], v[112:127]
    ds_read_b128 v[152:155], v3 offset:18432
    ds_read_b128 v[156:159], v3 offset:19456
    s_waitcnt lgkmcnt(4)
    v_mfma_f32_32x32x16_bf16 v[64:79], a[12:15], v[128:131], v[64:79]
    buffer_load_dwordx4 a[40:43], v3, s[16:19], s21 offen offset:2048 sc1
    v_mfma_f32_32x32x16_bf16 v[80:95], a[12:15], v[132:135], v[80:95]
    ds_read_b128 v[160:163], v3 offset:20480
    ds_read_b128 v[164:167], v3 offset:21504
    v_mfma_f32_32x32x16_bf16 v[96:111], a[12:15], v[136:139], v[96:111]
    buffer_load_dwordx4 a[44:47], v3, s[16:19], s21 offen offset:3072 sc1
    s_add_u32 s21, s21, 4096
    v_mfma_f32_32x32x16_bf16 v[112:127], a[12:15], v[140:143], v[112:127]
    ds_read_b128 v[168:171], v3 offset:22528
    ds_read_b128 v[172:175], v3 offset:23552
    s_waitcnt vmcnt(11) lgkmcnt(4)
    v_mfma_f32_32x32x16_bf16 v[64:79], a[16:19], v[144:147], v[64:79]
    s_add_u32 m0, s23, 49152
    s_nop 0
    buffer_load_dwordx4 v3, s[16:19], s22 offen offset:0 sc1 lds
    v_mfma_f32_32x32x16_bf16 v[80:95], a[16:19], v[148:151], v[80:95]
    ds_read_b128 v[128:131], v3 offset:24576
    ds_read_b128 v[132:135], v3 offset:25600
    v_mfma_f32_32x32x16_bf16 v[96:111], a[16:19], v[152:155], v[96:111]
    buffer_load_dwordx4 v3, s[16:19], s22 offen offset:1024 sc1 lds
    v_mfma_f32_32x32x16_bf16 v[112:127], a[16:19], v[156:159], v[112:127]
    ds_read_b128 v[136:139], v3 offset:26624
    ds_read_b128 v[140:143], v3 offset:27648
    s_waitcnt vmcnt(12) lgkmcnt(4)
    v_mfma_f32_32x32x16_bf16 v[64:79], a[20:23], v[160:163], v[64:79]
    buffer_load_dwordx4 v3, s[16:19], s22 offen offset:2048 sc1 lds
    v_mfma_f32_32x32x16_bf16 v[80:95], a[20:23], v[164:167], v[80:95]
    ds_read_b128 v[144:147], v3 offset:28672
    ds_read_b128 v[148:151], v3 offset:29696
    v_mfma_f32_32x32x16_bf16 v[96:111], a[20:23], v[168:171], v[96:111]
    buffer_load_dwordx4 v3, s[16:19], s22 offen offset:3072 sc1 lds
    s_add_u32 s22, s22, 16384
    v_mfma_f32_32x32x16_bf16 v[112:127], a[20:23], v[172:175], v[112:127]
    ds_read_b128 v[152:155], v3 offset:30720
    ds_read_b128 v[156:159], v3 offset:31744
    s_waitcnt vmcnt(13) lgkmcnt(4)
    v_mfma_f32_32x32x16_bf16 v[64:79], a[24:27], v[128:131], v[64:79]
    buffer_load_dwordx4 a[48:51], v3, s[16:19], s21 offen offset:0 sc1
    v_mfma_f32_32x32x16_bf16 v[80:95], a[24:27], v[132:135], v[80:95]
    s_waitcnt vmcnt(9)
    s_barrier
    ds_read_b128 v[160:163], v3 offset:32768
    ds_read_b128 v[164:167], v3 offset:33792
    v_mfma_f32_32x32x16_bf16 v[96:111], a[24:27], v[136:139], v[96:111]
    buffer_load_dwordx4 a[52:55], v3, s[16:19], s21 offen offset:1024 sc1
    v_mfma_f32_32x32x16_bf16 v[112:127], a[24:27], v[140:143], v[112:127]
    ds_read_b128 v[168:171], v3 offset:34816
    ds_read_b128 v[172:175], v3 offset:35840
    s_waitcnt lgkmcnt(4)
    v_mfma_f32_32x32x16_bf16 v[64:79], a[28:31], v[144:147], v[64:79]
    buffer_load_dwordx4 a[56:59], v3, s[16:19], s21 offen offset:2048 sc1
    v_mfma_f32_32x32x16_bf16 v[80:95], a[28:31], v[148:151], v[80:95]
    ds_read_b128 v[128:131], v3 offset:36864
    ds_read_b128 v[132:135], v3 offset:37888
    v_mfma_f32_32x32x16_bf16 v[96:111], a[28:31], v[152:155], v[96:111]
    buffer_load_dwordx4 a[60:63], v3, s[16:19], s21 offen offset:3072 sc1
    s_add_u32 s21, s21, 4096
    v_mfma_f32_32x32x16_bf16 v[112:127], a[28:31], v[156:159], v[112:127]
    ds_read_b128 v[136:139], v3 offset:38912
    ds_read_b128 v[140:143], v3 offset:39936
    s_waitcnt vmcnt(11) lgkmcnt(4)
    v_mfma_f32_32x32x16_bf16 v[64:79], a[32:35], v[160:163], v[64:79]
    s_add_u32 m0, s23, 65536
    s_nop 0
    buffer_load_dwordx4 v3, s[16:19], s22 offen offset:0 sc1 lds
    v_mfma_f32_32x32x16_bf16 v[80:95], a[32:35], v[164:167], v[80:95]
    ds_read_b128 v[144:147], v3 offset:40960
    ds_read_b128 v[148:151], v3 offset:41984
    v_mfma_f32_32x32x16_bf16 v[96:111], a[32:35], v[168:171], v[96:111]
    buffer_load_dwordx4 v3, s[16:19], s22 offen offset:1024 sc1 lds
    v_mfma_f32_32x32x16_bf16 v[112:127], a[32:35], v[172:175], v[112:127]
    ds_read_b128 v[152:155], v3 offset:43008
    ds_read_b128 v[156:159], v3 offset:44032
    s_waitcnt vmcnt(12) lgkmcnt(4)
    v_mfma_f32_32x32x16_bf16 v[64:79], a[36:39], v[128:131], v[64:79]
    buffer_load_dwordx4 v3, s[16:19], s22 offen offset:2048 sc1 lds
    v_mfma_f32_32x32x16_bf16 v[80:95], a[36:39], v[132:135], v[80:95]
    ds_read_b128 v[160:163], v3 offset:45056
    ds_read_b128 v[164:167], v3 offset:46080
    v_mfma_f32_32x32x16_bf16 v[96:111], a[36:39], v[136:139], v[96:111]
    buffer_load_dwordx4 v3, s[16:19], s22 offen offset:3072 sc1 lds
    s_add_u32 s22, s22, 16384
    v_mfma_f32_32x32x16_bf16 v[112:127], a[36:39], v[140:143], v[112:127]
    ds_read_b128 v[168:171], v3 offset:47104
    ds_read_b128 v[172:175], v3 offset:48128
    s_waitcnt vmcnt(13) lgkmcnt(4)
    v_mfma_f32_32x32x16_bf16 v[64:79], a[40:43], v[144:147], v[64:79]
    buffer_load_dwordx4 a[64:67], v3, s[16:19], s21 offen offset:0 sc1
    v_mfma_f32_32x32x16_bf16 v[80:95], a[40:43], v[148:151], v[80:95]
    s_waitcnt vmcnt(9)
    s_barrier
    s_cmp_lg_u32 s20, 1
    s_cbranch_scc1 sig2
    v_mov_b32 v7, 0
    s_lshl_b32 s42, s45, 2
    s_add_u32 s42, s42, 4096
    v_mov_b32 v6, s44
    s_mov_b64 exec, 1
    buffer_store_dword v6, v7, s[16:19], s42 offen sc1
    s_mov_b64 exec, -1
sig2:
    ds_read_b128 v[128:131], v3 offset:49152
    ds_read_b128 v[132:135], v3 offset:50176
    v_mfma_f32_32x32x16_bf16 v[96:111], a[40:43], v[152:155], v[96:111]
    buffer_load_dwordx4 a[68:71], v3, s[16:19], s21 offen offset:1024 sc1
    v_mfma_f32_32x32x16_bf16 v[112:127], a[40:43], v[156:159], v[112:127]
    ds_read_b128 v[136:139], v3 offset:51200
    ds_read_b128 v[140:143], v3 offset:52224
    s_waitcnt lgkmcnt(4)
    v_mfma_f32_32x32x16_bf16 v[64:79], a[44:47], v[160:163], v[64:79]
    buffer_load_dwordx4 a[72:75], v3, s[16:19], s21 offen offset:2048 sc1
    v_mfma_f32_32x32x16_bf16 v[80:95], a[44:47], v[164:167], v[80:95]
    ds_read_b128 v[144:147], v3 offset:53248
    ds_read_b128 v[148:151], v3 offset:54272
    v_mfma_f32_32x32x16_bf16 v[96:111], a[44:47], v[168:171], v[96:111]
    buffer_load_dwordx4 a[76:79], v3, s[16:19], s21 offen offset:3072 sc1
    s_add_u32 s21, s21, 4096
    v_mfma_f32_32x32x16_bf16 v[112:127], a[44:47], v[172:175], v[112:127]
    ds_read_b128 v[152:155], v3 offset:55296
    ds_read_b128 v[156:159], v3 offset:56320
    s_waitcnt vmcnt(11) lgkmcnt(4)
    v_mfma_f32_32x32x16_bf16 v[64:79], a[48:51], v[128:131], v[64:79]
    s_add_u32 m0, s23, 81920
    s_nop 0
    buffer_load_dwordx4 v3, s[16:19], s22 offen offset:0 sc1 lds
    v_mfma_f32_32x32x16_bf16 v[80:95], a[48:51], v[132:135], v[80:95]
    ds_read_b128 v[160:163], v3 offset:57344
    ds_read_b128 v[164:167], v3 offset:58368
    v_mfma_f32_32x32x16_bf16 v[96:111], a[48:51], v[136:139], v[96:111]
    buffer_load_dwordx4 v3, s[16:19], s22 offen offset:1024 sc1 lds
    v_mfma_f32_32x32x16_bf16 v[112:127], a[48:51], v[140:143], v[112:127]
    ds_read_b128 v[168:171], v3 offset:59392
    ds_read_b128 v[172:175], v3 offset:60416
    s_waitcnt vmcnt(12) lgkmcnt(4)
    v_mfma_f32_32x32x16_bf16 v[64:79], a[52:55], v[144:147], v[64:79]
    buffer_load_dwordx4 v3, s[16:19], s22 offen offset:2048 sc1 lds
    v_mfma_f32_32x32x16_bf16 v[80:95], a[52:55], v[148:151], v[80:95]
    ds_read_b128 v[128:131], v3 offset:61440
    ds_read_b128 v[132:135], v3 offset:62464
    v_mfma_f32_32x32x16_bf16 v[96:111], a[52:55], v[152:155], v[96:111]
    buffer_load_dwordx4 v3, s[16:19], s22 offen offset:3072 sc1 lds
    s_add_u32 s22, s22, 16384
    v_mfma_f32_32x32x16_bf16 v[112:127], a[52:55], v[156:159], v[112:127]
    ds_read_b128 v[136:139], v3 offset:63488
    ds_read_b128 v[140:143], v3 offset:64512
    s_waitcnt vmcnt(13) lgkmcnt(4)
    v_mfma_f32_32x32x16_bf16 v[64:79], a[56:59], v[160:163], v[64:79]
    buffer_load_dwordx4 a[80:83], v3, s[16:19], s21 offen offset:0 sc1
    v_mfma_f32_32x32x16_bf16 v[80:95], a[56:59], v[164:167], v[80:95]
    s_waitcnt vmcnt(9)
    s_barrier
    ds_read_b128 v[144:147], v4 offset:0
    ds_read_b128 v[148:151], v4 offset:1024
    v_mfma_f32_32x32x16_bf16 v[96:111], a[56:59], v[168:171], v[96:111]
    buffer_load_dwordx4 a[84:87], v3, s[16:19], s21 offen offset:1024 sc1
    v_mfma_f32_32x32x16_bf16 v[112:127], a[56:59], v[172:175], v[112:127]
    ds_read_b128 v[152:155], v4 offset:2048
    ds_read_b128 v[156:159], v4 offset:3072
    s_waitcnt lgkmcnt(4)
    v_mfma_f32_32x32x16_bf16 v[64:79], a[60:63], v[128:131], v[64:79]
    buffer_load_dwordx4 a[88:91], v3, s[16:19], s21 offen offset:2048 sc1
    v_mfma_f32_32x32x16_bf16 v[80:95], a[60:63], v[132:135], v[80:95]
    ds_read_b128 v[160:163], v4 offset:4096
    ds_read_b128 v[164:167], v4 offset:5120
    v_mfma_f32_32x32x16_bf16 v[96:111], a[60:63], v[136:139], v[96:111]
    buffer_load_dwordx4 a[92:95], v3, s[16:19], s21 offen offset:3072 sc1
    s_add_u32 s21, s21, 4096
    v_mfma_f32_32x32x16_bf16 v[112:127], a[60:63], v[140:143], v[112:127]
    ds_read_b128 v[168:171], v4 offset:6144
    ds_read_b128 v[172:175], v4 offset:7168
    s_waitcnt vmcnt(11) lgkmcnt(4)
    v_mfma_f32_32x32x16_bf16 v[64:79], a[64:67], v[144:147], v[64:79]
    s_add_u32 m0, s23, 98304
    s_nop 0
    buffer_load_dwordx4 v3, s[16:19], s22 offen offset:0 sc1 lds
    v_mfma_f32_32x32x16_bf16 v[80:95], a[64:67], v[148:151], v[80:95]
    ds_read_b128 v[128:131], v4 offset:8192
    ds_read_b128 v[132:135], v4 offset:9216
    v_mfma_f32_32x32x16_bf16 v[96:111], a[64:67], v[152:155], v[96:111]
    buffer_load_dwordx4 v3, s[16:19], s22 offen offset:1024 sc1 lds
    v_mfma_f32_32x32x16_bf16 v[112:127], a[64:67], v[156:159], v[112:127]
    ds_read_b128 v[136:139], v4 offset:10240
    ds_read_b128 v[140:143], v4 offset:11264
    s_waitcnt vmcnt(12) lgkmcnt(4)
    v_mfma_f32_32x32x16_bf16 v[64:79], a[68:71], v[160:163], v[64:79]
    buffer_load_dwordx4 v3, s[16:19], s22 offen offset:2048 sc1 lds
    v_mfma_f32_32x32x16_bf16 v[80:95], a[68:71], v[164:167], v[80:95]
    ds_read_b128 v[144:147], v4 offset:12288
    ds_read_b128 v[148:151], v4 offset:13312
    v_mfma_f32_32x32x16_bf16 v[96:111], a[68:71], v[168:171], v[96:111]
    buffer_load_dwordx4 v3, s[16:19], s22 offen offset:3072 sc1 lds
    s_add_u32 s22, s22, 16384
    v_mfma_f32_32x32x16_bf16 v[112:127], a[68:71], v[172:175], v[112:127]
    ds_read_b128 v[152:155], v4 offset:14336
    ds_read_b128 v[156:159], v4 offset:15360
    s_waitcnt vmcnt(13) lgkmcnt(4)
    v_mfma_f32_32x32x16_bf16 v[64:79], a[72:75], v[128:131], v[64:79]
    buffer_load_dwordx4 a[96:99], v3, s[16:19], s21 offen offset:0 sc1
    v_mfma_f32_32x32x16_bf16 v[80:95], a[72:75], v[132:135], v[80:95]
    s_waitcnt vmcnt(9)
    s_barrier
    ds_read_b128 v[160:163], v4 offset:16384
    ds_read_b128 v[164:167], v4 offset:17408
    v_mfma_f32_32x32x16_bf16 v[96:111], a[72:75], v[136:139], v[96:111]
    buffer_load_dwordx4 a[100:103], v3, s[16:19], s21 offen offset:1024 sc1
    v_mfma_f32_32x32x16_bf16 v[112:127], a[72:75], v[140:143], v[112:127]
    ds_read_b128 v[168:171], v4 offset:18432
    ds_read_b128 v[172:175], v4 offset:19456
    s_waitcnt lgkmcnt(4)
    v_mfma_f32_32x32x16_bf16 v[64:79], a[76:79], v[144:147], v[64:79]
    buffer_load_dwordx4 a[104:107], v3, s[16:19], s21 offen offset:2048 sc1
    v_mfma_f32_32x32x16_bf16 v[80:95], a[76:79], v[148:151], v[80:95]
    ds_read_b128 v[128:131], v4 offset:20480
    ds_read_b128 v[132:135], v4 offset:21504
    v_mfma_f32_32x32x16_bf16 v[96:111], a[76:79], v[152:155], v[96:111]
    buffer_load_dwordx4 a[108:111], v3, s[16:19], s21 offen offset:3072 sc1
    s_add_u32 s21, s21, 4096
    v_mfma_f32_32x32x16_bf16 v[112:127], a[76:79], v[156:159], v[112:127]
    ds_read_b128 v[136:139], v4 offset:22528
    ds_read_b128 v[140:143], v4 offset:23552
    s_waitcnt vmcnt(11) lgkmcnt(4)
    v_mfma_f32_32x32x16_bf16 v[64:79], a[80:83], v[160:163], v[64:79]
    s_add_u32 m0, s23, 114688
    s_nop 0
    buffer_load_dwordx4 v3, s[16:19], s22 offen offset:0 sc1 lds
    v_mfma_f32_32x32x16_bf16 v[80:95], a[80:83], v[164:167], v[80:95]
    ds_read_b128 v[144:147], v4 offset:24576
    ds_read_b128 v[148:151], v4 offset:25600
    v_mfma_f32_32x32x16_bf16 v[96:111], a[80:83], v[168:171], v[96:111]
    buffer_load_dwordx4 v3, s[16:19], s22 offen offset:1024 sc1 lds
    v_mfma_f32_32x32x16_bf16 v[112:127], a[80:83], v[172:175], v[112:127]
    ds_read_b128 v[152:155], v4 offset:26624
    ds_read_b128 v[156:159], v4 offset:27648
    s_waitcnt vmcnt(12) lgkmcnt(4)
    v_mfma_f32_32x32x16_bf16 v[64:79], a[84:87], v[128:131], v[64:79]
    buffer_load_dwordx4 v3, s[16:19], s22 offen offset:2048 sc1 lds
    v_mfma_f32_32x32x16_bf16 v[80:95], a[84:87], v[132:135], v[80:95]
    ds_read_b128 v[160:163], v4 offset:28672
    ds_read_b128 v[164:167], v4 offset:29696
    v_mfma_f32_32x32x16_bf16 v[96:111], a[84:87], v[136:139], v[96:111]
    buffer_load_dwordx4 v3, s[16:19], s22 offen offset:3072 sc1 lds
    s_add_u32 s22, s22, 16384
    v_mfma_f32_32x32x16_bf16 v[112:127], a[84:87], v[140:143], v[112:127]
    ds_read_b128 v[168:171], v4 offset:30720
    ds_read_b128 v[172:175], v4 offset:31744
    s_waitcnt vmcnt(13) lgkmcnt(4)
    v_mfma_f32_32x32x16_bf16 v[64:79], a[88:91], v[144:147], v[64:79]
    buffer_load_dwordx4 a[112:115], v3, s[16:19], s21 offen offset:0 sc1
    v_mfma_f32_32x32x16_bf16 v[80:95], a[88:91], v[148:151], v[80:95]
    s_waitcnt vmcnt(9)
    s_barrier
    ds_read_b128 v[128:131], v4 offset:32768
    ds_read_b128 v[132:135], v4 offset:33792
    v_mfma_f32_32x32x16_bf16 v[96:111], a[88:91], v[152:155], v[96:111]
    buffer_load_dwordx4 a[116:119], v3, s[16:19], s21 offen offset:1024 sc1
    v_mfma_f32_32x32x16_bf16 v[112:127], a[88:91], v[156:159], v[112:127]
    ds_read_b128 v[136:139], v4 offset:34816
    ds_read_b128 v[140:143], v4 offset:35840
    s_waitcnt lgkmcnt(4)
    v_mfma_f32_32x32x16_bf16 v[64:79], a[92:95], v[160:163], v[64:79]
    buffer_load_dwordx4 a[120:123], v3, s[16:19], s21 offen offset:2048 sc1
    v_mfma_f32_32x32x16_bf16 v[80:95], a[92:95], v[164:167], v[80:95]
    ds_read_b128 v[144:147], v4 offset:36864
    ds_read_b128 v[148:151], v4 offset:37888
    v_mfma_f32_32x32x16_bf16 v[96:111], a[92:95], v[168:171], v[96:111]
    buffer_load_dwordx4 a[124:127], v3, s[16:19], s21 offen offset:3072 sc1
    s_add_u32 s21, s21, 4096
    v_mfma_f32_32x32x16_bf16 v[112:127], a[92:95], v[172:175], v[112:127]
    ds_read_b128 v[152:155], v4 offset:38912
    ds_read_b128 v[156:159], v4 offset:39936
    s_waitcnt vmcnt(11) lgkmcnt(4)
    v_mfma_f32_32x32x16_bf16 v[64:79], a[96:99], v[128:131], v[64:79]
    s_add_u32 m0, s23, 0
    s_nop 0
    buffer_load_dwordx4 v3, s[16:19], s22 offen offset:0 sc1 lds
    v_mfma_f32_32x32x16_bf16 v[80:95], a[96:99], v[132:135], v[80:95]
    ds_read_b128 v[160:163], v4 offset:40960
    ds_read_b128 v[164:167], v4 offset:41984
    v_mfma_f32_32x32x16_bf16 v[96:111], a[96:99], v[136:139], v[96:111]
    buffer_load_dwordx4 v3, s[16:19], s22 offen offset:1024 sc1 lds
    v_mfma_f32_32x32x16_bf16 v[112:127], a[96:99], v[140:143], v[112:127]
    ds_read_b128 v[168:171], v4 offset:43008
    ds_read_b128 v[172:175], v4 offset:44032
    s_waitcnt vmcnt(12) lgkmcnt(4)
    v_mfma_f32_32x32x16_bf16 v[64:79], a[100:103], v[144:147], v[64:79]
    buffer_load_dwordx4 v3, s[16:19], s22 offen offset:2048 sc1 lds
    v_mfma_f32_32x32x16_bf16 v[80:95], a[100:103], v[148:151], v[80:95]
    ds_read_b128 v[128:131], v4 offset:45056
    ds_read_b128 v[132:135], v4 offset:46080
    v_mfma_f32_32x32x16_bf16 v[96:111], a[100:103], v[152:155], v[96:111]
    buffer_load_dwordx4 v3, s[16:19], s22 offen offset:3072 sc1 lds
    s_add_u32 s22, s22, 16384
    v_mfma_f32_32x32x16_bf16 v[112:127], a[100:103], v[156:159], v[112:127]
    ds_read_b128 v[136:139], v4 offset:47104
    ds_read_b128 v[140:143], v4 offset:48128
    s_waitcnt vmcnt(13) lgkmcnt(4)
    v_mfma_f32_32x32x16_bf16 v[64:79], a[104:107], v[160:163], v[64:79]
    buffer_load_dwordx4 a[128:131], v3, s[16:19], s21 offen offset:0 sc1
    v_mfma_f32_32x32x16_bf16 v[80:95], a[104:107], v[164:167], v[80:95]
    s_waitcnt vmcnt(9)
    s_barrier
    ds_read_b128 v[144:147], v4 offset:49152
    ds_read_b128 v[148:151], v4 offset:50176
    v_mfma_f32_32x32x16_bf16 v[96:111], a[104:107], v[168:171], v[96:111]
    buffer_load_dwordx4 a[132:135], v3, s[16:19], s21 offen offset:1024 sc1
    v_mfma_f32_32x32x16_bf16 v[112:127], a[104:107], v[172:175], v[112:127]
    ds_read_b128 v[152:155], v4 offset:51200
    ds_read_b128 v[156:159], v4 offset:52224
    s_waitcnt lgkmcnt(4)
    v_mfma_f32_32x32x16_bf16 v[64:79], a[108:111], v[128:131], v[64:79]
    buffer_load_dwordx4 a[136:139], v3, s[16:19], s21 offen offset:2048 sc1
    v_mfma_f32_32x32x16_bf16 v[80:95], a[108:111], v[132:135], v[80:95]
    ds_read_b128 v[160:163], v4 offset:53248
    ds_read_b128 v[164:167], v4 offset:54272
    v_mfma_f32_32x32x16_bf16 v[96:111], a[108:111], v[136:139], v[96:111]
    buffer_load_dwordx4 a[140:143], v3, s[16:19], s21 offen offset:3072 sc1
    s_add_u32 s21, s21, 4096
    v_mfma_f32_32x32x16_bf16 v[112:127], a[108:111], v[140:143], v[112:127]
    ds_read_b128 v[168:171], v4 offset:55296
    ds_read_b128 v[172:175], v4 offset:56320
    s_waitcnt vmcnt(11) lgkmcnt(4)
    v_mfma_f32_32x32x16_bf16 v[64:79], a[112:115], v[144:147], v[64:79]
    s_add_u32 m0, s23, 16384
    s_nop 0
    buffer_load_dwordx4 v3, s[16:19], s22 offen offset:0 sc1 lds
    s_mov_b32 s42, 4096
    buffer_load_dwordx4 v[20:23], v3, s[16:19], s42 offen sc1
    v_mfma_f32_32x32x16_bf16 v[80:95], a[112:115], v[148:151], v[80:95]
    ds_read_b128 v[128:131], v4 offset:57344
    ds_read_b128 v[132:135], v4 offset:58368
    v_mfma_f32_32x32x16_bf16 v[96:111], a[112:115], v[152:155], v[96:111]
    buffer_load_dwordx4 v3, s[16:19], s22 offen offset:1024 sc1 lds
    v_mfma_f32_32x32x16_bf16 v[112:127], a[112:115], v[156:159], v[112:127]
    ds_read_b128 v[136:139], v4 offset:59392
    ds_read_b128 v[140:143], v4 offset:60416
    s_waitcnt vmcnt(13) lgkmcnt(4)
    v_mfma_f32_32x32x16_bf16 v[64:79], a[116:119], v[160:163], v[64:79]
    buffer_load_dwordx4 v3, s[16:19], s22 offen offset:2048 sc1 lds
    v_mfma_f32_32x32x16_bf16 v[80:95], a[116:119], v[164:167], v[80:95]
    ds_read_b128 v[144:147], v4 offset:61440
    ds_read_b128 v[148:151], v4 offset:62464
    v_mfma_f32_32x32x16_bf16 v[96:111], a[116:119], v[168:171], v[96:111]
    buffer_load_dwordx4 v3, s[16:19], s22 offen offset:3072 sc1 lds
    s_add_u32 s22, s22, 16384
    v_mfma_f32_32x32x16_bf16 v[112:127], a[116:119], v[172:175], v[112:127]
    ds_read_b128 v[152:155], v4 offset:63488
    ds_read_b128 v[156:159], v4 offset:64512
    s_waitcnt vmcnt(14) lgkmcnt(4)
    v_mfma_f32_32x32x16_bf16 v[64:79], a[120:123], v[128:131], v[64:79]
    buffer_load_dwordx4 a[144:147], v3, s[16:19], s21 offen offset:0 sc1
    v_mfma_f32_32x32x16_bf16 v[80:95], a[120:123], v[132:135], v[80:95]
    s_waitcnt vmcnt(10)
    s_barrier
    ds_read_b128 v[160:163], v3 offset:0
    ds_read_b128 v[164:167], v3 offset:1024
    v_mfma_f32_32x32x16_bf16 v[96:111], a[120:123], v[136:139], v[96:111]
    buffer_load_dwordx4 a[148:151], v3, s[16:19], s21 offen offset:1024 sc1
    v_mfma_f32_32x32x16_bf16 v[112:127], a[120:123], v[140:143], v[112:127]
    ds_read_b128 v[168:171], v3 offset:2048
    ds_read_b128 v[172:175], v3 offset:3072
    s_waitcnt lgkmcnt(4)
    v_mfma_f32_32x32x16_bf16 v[64:79], a[124:127], v[144:147], v[64:79]
    buffer_load_dwordx4 a[152:155], v3, s[16:19], s21 offen offset:2048 sc1
    ds_read_b64_tr_b16 v[32:33], v52
    ds_read_b64_tr_b16 v[34:35], v57
    ds_read_b64_tr_b16 v[36:37], v53
    ds_read_b64_tr_b16 v[38:39], v58
    ds_read_b64_tr_b16 v[40:41], v54
    ds_read_b64_tr_b16 v[42:43], v59
    v_mfma_f32_32x32x16_bf16 v[80:95], a[124:127], v[148:151], v[80:95]
    ds_read_b128 v[128:131], v3 offset:4096
    ds_read_b128 v[132:135], v3 offset:5120
    ds_read_b64_tr_b16 v[44:45], v55
    ds_read_b64_tr_b16 v[46:47], v60
    ds_read_b64_tr_b16 v[48:49], v56
    ds_read_b64_tr_b16 v[50:51], v61
    v_mfma_f32_32x32x16_bf16 v[96:111], a[124:127], v[152:155], v[96:111]
    buffer_load_dwordx4 a[156:159], v3, s[16:19], s21 offen offset:3072 sc1
    s_add_u32 s21, s21, 4096
    v_mfma_f32_32x32x16_bf16 v[112:127], a[124:127], v[156:159], v[112:127]
    ds_read_b128 v[136:139], v3 offset:6144
    ds_read_b128 v[140:143], v3 offset:7168
    s_waitcnt vmcnt(12) lgkmcnt(14)
    v_mfma_f32_32x32x16_bf16 v[64:79], a[128:131], v[160:163], v[64:79]
    s_waitcnt vmcnt(7)
    v_xor_b32 v20, s44, v20
    v_xor_b32 v21, s44, v21
    v_xor_b32 v22, s44, v22
    v_xor_b32 v23, s44, v23
    v_or3_b32 v20, v20, v21, v22
    v_or_b32 v20, v20, v23
    v_cmp_ne_u32 vcc, 0, v20
    s_cbranch_vccz p1_okkv
    s_mov_b32 s42, 4096
    s_mov_b32 s43, 0x20000
poll2:
    buffer_load_dwordx4 v[20:23], v3, s[16:19], s42 offen sc1
    s_waitcnt vmcnt(0)
    v_xor_b32 v20, s44, v20
    v_xor_b32 v21, s44, v21
    v_xor_b32 v22, s44, v22
    v_xor_b32 v23, s44, v23
    v_or3_b32 v20, v20, v21, v22
    v_or_b32 v20, v20, v23
    v_cmp_ne_u32 vcc, 0, v20
    s_cbranch_vccz poll2d
    s_sleep 8
    s_sub_u32 s43, s43, 1
    s_cbranch_scc0 poll2
poll2d:
p1_okkv:
    v_mfma_f32_32x32x16_bf16 v[80:95], a[128:131], v[164:167], v[80:95]
    ds_read_b128 v[144:147], v3 offset:8192
    ds_read_b128 v[148:151], v3 offset:12288
    v_mfma_f32_32x32x16_bf16 v[96:111], a[128:131], v[168:171], v[96:111]
    v_mov_b32 v63, 0
    s_mov_b32 s6, 0x3f803f80
    s_waitcnt lgkmcnt(14)
    buffer_store_dwordx4 v[32:35], v3, s[8:11], s24 offen sc1
    s_add_u32 s24, s24, s25
    v_dot2_f32_bf16 v63, v32, s6, v63
    v_dot2_f32_bf16 v63, v33, s6, v63
    v_dot2_f32_bf16 v63, v34, s6, v63
    v_mfma_f32_32x32x16_bf16 v[112:127], a[128:131], v[172:175], v[112:127]
    s_waitcnt vmcnt(5)
    s_barrier
    ds_read_b128 v[152:155], v3 offset:16384
    ds_read_b128 v[156:159], v3 offset:20480
    v_dot2_f32_bf16 v63, v35, s6, v63
    s_waitcnt lgkmcnt(14)
    buffer_store_dwordx4 v[36:39], v3, s[8:11], s24 offen sc1
    s_add_u32 s24, s24, s25
    v_dot2_f32_bf16 v63, v36, s6, v63
    v_dot2_f32_bf16 v63, v37, s6, v63
    v_dot2_f32_bf16 v63, v38, s6, v63
    v_dot2_f32_bf16 v63, v39, s6, v63
    s_waitcnt lgkmcnt(4)
    v_mfma_f32_32x32x16_bf16 v[64:79], a[132:135], v[128:131], v[64:79]
    buffer_store_dwordx4 v[40:43], v3, s[8:11], s24 offen sc1
    s_add_u32 s24, s24, s25
    v_dot2_f32_bf16 v63, v40, s6, v63
    v_dot2_f32_bf16 v63, v41, s6, v63
    v_dot2_f32_bf16 v63, v42, s6, v63
    v_dot2_f32_bf16 v63, v43, s6, v63
    buffer_store_dwordx4 v[44:47], v3, s[8:11], s24 offen sc1
    s_add_u32 s24, s24, s25
    v_mfma_f32_32x32x16_bf16 v[80:95], a[132:135], v[132:135], v[80:95]
    ds_read_b128 v[160:163], v3 offset:24576
    ds_read_b128 v[164:167], v3 offset:28672
    v_dot2_f32_bf16 v63, v44, s6, v63
    v_dot2_f32_bf16 v63, v45, s6, v63
    v_dot2_f32_bf16 v63, v46, s6, v63
    v_dot2_f32_bf16 v63, v47, s6, v63
    buffer_store_dwordx4 v[48:51], v3, s[8:11], s24 offen sc1
    s_add_u32 s24, s24, s25
    v_dot2_f32_bf16 v63, v48, s6, v63
    v_mfma_f32_32x32x16_bf16 v[96:111], a[132:135], v[136:139], v[96:111]
    v_dot2_f32_bf16 v63, v49, s6, v63
    v_dot2_f32_bf16 v63, v50, s6, v63
    v_dot2_f32_bf16 v63, v51, s6, v63
    s_nop 2
    v_mov_b32 v52, v63
    s_nop 0
    s_nop 0
    v_permlane32_swap_b32 v63, v52
    v_add_f32 v63, v63, v52
    v_mfma_f32_32x32x16_bf16 v[112:127], a[132:135], v[140:143], v[112:127]
    ds_read_b128 v[168:171], v3 offset:9216
    ds_read_b128 v[172:175], v3 offset:13312
    buffer_store_dword v63, v62, s[8:11], s37 offen sc1
    s_waitcnt vmcnt(8) lgkmcnt(4)
    v_mfma_f32_32x32x16_bf16 v[64:79], a[136:139], v[144:147], v[64:79]
    v_mfma_f32_32x32x16_bf16 v[64:79], a[140:143], v[148:151], v[64:79]
    ds_read_b128 v[128:131], v3 offset:17408
    ds_read_b128 v[132:135], v3 offset:21504
    v_mfma_f32_32x32x16_bf16 v[64:79], a[144:147], v[152:155], v[64:79]
    buffer_load_dwordx4 a[160:163], v3, s[16:19], s31 offen offset:0 sc1
    v_mfma_f32_32x32x16_bf16 v[64:79], a[148:151], v[156:159], v[64:79]
    ds_read_b128 v[136:139], v3 offset:25600
    ds_read_b128 v[140:143], v3 offset:29696
    s_waitcnt vmcnt(7) lgkmcnt(4)
    v_mfma_f32_32x32x16_bf16 v[64:79], a[152:155], v[160:163], v[64:79]
    v_mfma_f32_32x32x16_bf16 v[64:79], a[156:159], v[164:167], v[64:79]
    buffer_load_dwordx4 a[164:167], v3, s[16:19], s31 offen offset:1024 sc1
    ds_read_b128 v[144:147], v3 offset:10240
    ds_read_b128 v[148:151], v3 offset:11264
    v_mfma_f32_32x32x16_bf16 v[80:95], a[136:139], v[168:171], v[80:95]
    v_mfma_f32_32x32x16_bf16 v[80:95], a[140:143], v[172:175], v[80:95]
    ds_read_b128 v[152:155], v3 offset:14336
    ds_read_b128 v[156:159], v3 offset:15360
    s_nop 4
    v_pk_mul_f32 v[8:9], v[64:65], s[40:41]
    v_pk_mul_f32 v[10:11], v[66:67], s[40:41]
    v_exp_f32_e64 v8, v8 clamp
    v_exp_f32_e64 v9, v9 clamp
    v_exp_f32_e64 v10, v10 clamp
    v_exp_f32_e64 v11, v11 clamp
    s_waitcnt lgkmcnt(4)
    v_mfma_f32_32x32x16_bf16 v[80:95], a[144:147], v[128:131], v[80:95]
    buffer_load_dwordx4 a[168:171], v3, s[16:19], s31 offen offset:2048 sc1
    v_max_f32 v12, 0, v64
    v_max_f32 v13, 0, v65
    v_max_f32 v14, 0, v66
    v_max_f32 v15, 0, v67
    v_pk_add_f32 v[8:9], v[8:9], s[38:39]
    v_pk_add_f32 v[10:11], v[10:11], s[38:39]
    v_mfma_f32_32x32x16_bf16 v[80:95], a[148:151], v[132:135], v[80:95]
    ds_read_b128 v[160:163], v3 offset:18432
    ds_read_b128 v[164:167], v3 offset:19456
    v_pk_add_f32 v[8:9], v[8:9], v[12:13]
    v_pk_add_f32 v[10:11], v[10:11], v[14:15]
    v_cvt_pk_bf16_f32 v176, v8, v9
    v_cvt_pk_bf16_f32 v177, v10, v11
    v_pk_mul_f32 v[8:9], v[68:69], s[40:41]
    v_pk_mul_f32 v[10:11], v[70:71], s[40:41]
    v_mfma_f32_32x32x16_bf16 v[80:95], a[152:155], v[136:139], v[80:95]
    v_exp_f32_e64 v8, v8 clamp
    v_exp_f32_e64 v9, v9 clamp
    v_exp_f32_e64 v10, v10 clamp
    buffer_load_dwordx4 a[172:175], v3, s[16:19], s31 offen offset:3072 sc1
    s_add_u32 s31, s31, 4096
    v_exp_f32_e64 v11, v11 clamp
    v_max_f32 v12, 0, v68
    v_max_f32 v13, 0, v69
    v_mfma_f32_32x32x16_bf16 v[80:95], a[156:159], v[140:143], v[80:95]
    ds_read_b128 v[168:171], v3 offset:22528
    ds_read_b128 v[172:175], v3 offset:23552
    v_max_f32 v14, 0, v70
    v_max_f32 v15, 0, v71
    v_pk_add_f32 v[8:9], v[8:9], s[38:39]
    v_pk_add_f32 v[10:11], v[10:11], s[38:39]
    v_pk_add_f32 v[8:9], v[8:9], v[12:13]
    v_pk_add_f32 v[10:11], v[10:11], v[14:15]
    s_waitcnt lgkmcnt(4)
    v_mfma_f32_32x32x16_bf16 v[96:111], a[136:139], v[144:147], v[96:111]
    v_cvt_pk_bf16_f32 v178, v8, v9
    v_cvt_pk_bf16_f32 v179, v10, v11
    v_pk_mul_f32 v[8:9], v[72:73], s[40:41]
    v_pk_mul_f32 v[10:11], v[74:75], s[40:41]
    v_exp_f32_e64 v8, v8 clamp
    buffer_load_dwordx4 a[176:179], v3, s[16:19], s31 offen offset:0 sc1
    v_exp_f32_e64 v9, v9 clamp
    v_mfma_f32_32x32x16_bf16 v[112:127], a[136:139], v[148:151], v[112:127]
    ds_read_b128 v[128:131], v3 offset:26624
    ds_read_b128 v[132:135], v3 offset:27648
    v_exp_f32_e64 v10, v10 clamp
    v_exp_f32_e64 v11, v11 clamp
    v_max_f32 v12, 0, v72
    v_max_f32 v13, 0, v73
    v_max_f32 v14, 0, v74
    v_max_f32 v15, 0, v75
    v_mfma_f32_32x32x16_bf16 v[96:111], a[140:143], v[152:155], v[96:111]
    v_pk_add_f32 v[8:9], v[8:9], s[38:39]
    v_pk_add_f32 v[10:11], v[10:11], s[38:39]
    v_pk_add_f32 v[8:9], v[8:9], v[12:13]
    v_pk_add_f32 v[10:11], v[10:11], v[14:15]
    v_cvt_pk_bf16_f32 v180, v8, v9
    v_cvt_pk_bf16_f32 v181, v10, v11
    v_mfma_f32_32x32x16_bf16 v[112:127], a[140:143], v[156:159], v[112:127]
    buffer_load_dwordx4 a[180:183], v3, s[16:19], s31 offen offset:1024 sc1
    ds_read_b128 v[136:139], v3 offset:30720
    ds_read_b128 v[140:143], v3 offset:31744
    v_pk_mul_f32 v[8:9], v[76:77], s[40:41]
    v_pk_mul_f32 v[10:11], v[78:79], s[40:41]
    v_exp_f32_e64 v8, v8 clamp
    v_exp_f32_e64 v9, v9 clamp
    v_exp_f32_e64 v10, v10 clamp
    v_exp_f32_e64 v11, v11 clamp
    s_waitcnt lgkmcnt(4)
    v_mfma_f32_32x32x16_bf16 v[96:111], a[144:147], v[160:163], v[96:111]
    v_max_f32 v12, 0, v76
    v_max_f32 v13, 0, v77
    v_max_f32 v14, 0, v78
    v_max_f32 v15, 0, v79
    v_pk_add_f32 v[8:9], v[8:9], s[38:39]
    v_pk_add_f32 v[10:11], v[10:11], s[38:39]
    v_mfma_f32_32x32x16_bf16 v[112:127], a[144:147], v[164:167], v[112:127]
    v_pk_add_f32 v[8:9], v[8:9], v[12:13]
    buffer_load_dwordx4 a[184:187], v3, s[16:19], s31 offen offset:2048 sc1
    v_pk_add_f32 v[10:11], v[10:11], v[14:15]
    v_cvt_pk_bf16_f32 v182, v8, v9
    v_cvt_pk_bf16_f32 v183, v10, v11
    ds_write_b128 v240, v[176:179] offset:0
    ds_write_b128 v240, v[180:183] offset:1024
    v_mfma_f32_32x32x16_bf16 v[96:111], a[148:151], v[168:171], v[96:111]
    v_pk_mul_f32 v[8:9], v[80:81], s[40:41]
    v_pk_mul_f32 v[10:11], v[82:83], s[40:41]
    v_exp_f32_e64 v8, v8 clamp
    v_exp_f32_e64 v9, v9 clamp
    v_exp_f32_e64 v10, v10 clamp
    v_exp_f32_e64 v11, v11 clamp
    v_mfma_f32_32x32x16_bf16 v[112:127], a[148:151], v[172:175], v[112:127]
    v_max_f32 v12, 0, v80
    v_max_f32 v13, 0, v81
    v_max_f32 v14, 0, v82
    v_max_f32 v15, 0, v83
    buffer_load_dwordx4 a[188:191], v3, s[16:19], s31 offen offset:3072 sc1
    s_add_u32 s31, s31, 4096
    v_pk_add_f32 v[8:9], v[8:9], s[38:39]
    v_pk_add_f32 v[10:11], v[10:11], s[38:39]
    s_waitcnt lgkmcnt(2)
    v_mfma_f32_32x32x16_bf16 v[96:111], a[152:155], v[128:131], v[96:111]
    v_pk_add_f32 v[8:9], v[8:9], v[12:13]
    v_pk_add_f32 v[10:11], v[10:11], v[14:15]
    v_cvt_pk_bf16_f32 v184, v8, v9
    v_cvt_pk_bf16_f32 v185, v10, v11
    v_pk_mul_f32 v[8:9], v[84:85], s[40:41]
    v_pk_mul_f32 v[10:11], v[86:87], s[40:41]
    v_mfma_f32_32x32x16_bf16 v[112:127], a[152:155], v[132:135], v[112:127]
    v_exp_f32_e64 v8, v8 clamp
    v_exp_f32_e64 v9, v9 clamp
    v_exp_f32_e64 v10, v10 clamp
    v_exp_f32_e64 v11, v11 clamp
    v_max_f32 v12, 0, v84
    v_max_f32 v13, 0, v85
    buffer_load_dwordx4 a[192:195], v3, s[16:19], s31 offen offset:0 sc1
    v_mfma_f32_32x32x16_bf16 v[96:111], a[156:159], v[136:139], v[96:111]
    v_max_f32 v14, 0, v86
    v_max_f32 v15, 0, v87
    v_pk_add_f32 v[8:9], v[8:9], s[38:39]
    v_pk_add_f32 v[10:11], v[10:11], s[38:39]
    v_pk_add_f32 v[8:9], v[8:9], v[12:13]
    v_pk_add_f32 v[10:11], v[10:11], v[14:15]
    v_mfma_f32_32x32x16_bf16 v[112:127], a[156:159], v[140:143], v[112:127]
    v_cvt_pk_bf16_f32 v186, v8, v9
    v_cvt_pk_bf16_f32 v187, v10, v11
    v_pk_mul_f32 v[8:9], v[88:89], s[40:41]
    v_pk_mul_f32 v[10:11], v[90:91], s[40:41]
    v_exp_f32_e64 v8, v8 clamp
    v_exp_f32_e64 v9, v9 clamp
    v_exp_f32_e64 v10, v10 clamp
    v_exp_f32_e64 v11, v11 clamp
    buffer_load_dwordx4 a[196:199], v3, s[16:19], s31 offen offset:1024 sc1
    v_max_f32 v12, 0, v88
    v_max_f32 v13, 0, v89
    v_max_f32 v14, 0, v90
    v_max_f32 v15, 0, v91
    v_pk_add_f32 v[8:9], v[8:9], s[38:39]
    v_pk_add_f32 v[10:11], v[10:11], s[38:39]
    v_pk_add_f32 v[8:9], v[8:9], v[12:13]
    v_pk_add_f32 v[10:11], v[10:11], v[14:15]
    v_cvt_pk_bf16_f32 v188, v8, v9
    v_cvt_pk_bf16_f32 v189, v10, v11
    v_pk_mul_f32 v[8:9], v[92:93], s[40:41]
    v_pk_mul_f32 v[10:11], v[94:95], s[40:41]
    v_exp_f32_e64 v8, v8 clamp
    v_exp_f32_e64 v9, v9 clamp
    v_exp_f32_e64 v10, v10 clamp
    v_exp_f32_e64 v11, v11 clamp
    v_max_f32 v12, 0, v92
    buffer_load_dwordx4 a[200:203], v3, s[16:19], s31 offen offset:2048 sc1
    v_max_f32 v13, 0, v93
    v_max_f32 v14, 0, v94
    v_max_f32 v15, 0, v95
    v_pk_add_f32 v[8:9], v[8:9], s[38:39]
    v_pk_add_f32 v[10:11], v[10:11], s[38:39]
    v_pk_add_f32 v[8:9], v[8:9], v[12:13]
    v_pk_add_f32 v[10:11], v[10:11], v[14:15]
    v_cvt_pk_bf16_f32 v190, v8, v9
    v_cvt_pk_bf16_f32 v191, v10, v11
    ds_write_b128 v240, v[184:187] offset:2048
    ds_write_b128 v240, v[188:191] offset:3072
    v_cvt_pk_bf16_f32 v192, v96, v97
    v_cvt_pk_bf16_f32 v193, v98, v99
    v_cvt_pk_bf16_f32 v194, v100, v101
    v_cvt_pk_bf16_f32 v195, v102, v103
    v_cvt_pk_bf16_f32 v196, v104, v105
    v_cvt_pk_bf16_f32 v197, v106, v107
    v_cvt_pk_bf16_f32 v198, v108, v109
    v_cvt_pk_bf16_f32 v199, v110, v111
    ds_write_b128 v240, v[192:195] offset:4096
    buffer_load_dwordx4 a[204:207], v3, s[16:19], s31 offen offset:3072 sc1
    s_add_u32 s31, s31, 4096
    ds_write_b128 v240, v[196:199] offset:5120
    v_cvt_pk_bf16_f32 v200, v112, v113
    v_cvt_pk_bf16_f32 v201, v114, v115
    v_cvt_pk_bf16_f32 v202, v116, v117
    v_cvt_pk_bf16_f32 v203, v118, v119
    v_cvt_pk_bf16_f32 v204, v120, v121
    v_cvt_pk_bf16_f32 v205, v122, v123
    v_cvt_pk_bf16_f32 v206, v124, v125
    v_cvt_pk_bf16_f32 v207, v126, v127
    s_mov_b32 s34, 0xf0000000
    s_mov_b32 s35, 0xf0000000
    v_mov_b32 v7, 0x3f803f80
    v_cndmask_b32 v200, v200, v7, s[34:35]
    v_cndmask_b32 v201, v201, v7, s[34:35]
    v_cndmask_b32 v202, v202, v7, s[34:35]
    v_cndmask_b32 v203, v203, v7, s[34:35]
    v_cndmask_b32 v204, v204, v7, s[34:35]
    v_cndmask_b32 v205, v205, v7, s[34:35]
    v_cndmask_b32 v206, v206, v7, s[34:35]
    v_cndmask_b32 v207, v207, v7, s[34:35]
    ds_write_b128 v240, v[200:203] offset:6144
    buffer_load_dwordx4 a[208:211], v3, s[16:19], s31 offen offset:0 sc1
    ds_write_b128 v240, v[204:207] offset:7168
    s_waitcnt lgkmcnt(0)
    s_barrier
    ds_read_b128 v[64:67], v236 offset:0
    ds_read_b128 v[96:99], v237 offset:0
    ds_read_b128 v[68:71], v236 offset:1024
    ds_read_b128 v[100:103], v237 offset:1024
    ds_read_b128 v[72:75], v236 offset:8192
    ds_read_b128 v[104:107], v237 offset:8192
    ds_read_b128 v[76:79], v236 offset:9216
    ds_read_b128 v[108:111], v237 offset:9216
    ds_read_b128 v[80:83], v236 offset:16384
    ds_read_b128 v[112:115], v237 offset:16384
    ds_read_b128 v[84:87], v236 offset:17408
    ds_read_b128 v[116:119], v237 offset:17408
    buffer_load_dwordx4 a[212:215], v3, s[16:19], s31 offen offset:1024 sc1
    ds_read_b128 v[88:91], v236 offset:24576
    ds_read_b128 v[120:123], v237 offset:24576
    ds_read_b128 v[92:95], v236 offset:25600
    ds_read_b128 v[124:127], v237 offset:25600
    s_waitcnt lgkmcnt(14)
    v_mfma_f32_32x32x16_bf16 v[128:143], v[64:67], v[96:99], 0
    s_waitcnt lgkmcnt(12)
    v_mfma_f32_32x32x16_bf16 v[128:143], v[68:71], v[100:103], v[128:143]
    s_waitcnt lgkmcnt(10)
    v_mfma_f32_32x32x16_bf16 v[128:143], v[72:75], v[104:107], v[128:143]
    buffer_load_dwordx4 a[216:219], v3, s[16:19], s31 offen offset:2048 sc1
    s_waitcnt lgkmcnt(8)
    v_mfma_f32_32x32x16_bf16 v[128:143], v[76:79], v[108:111], v[128:143]
    s_waitcnt lgkmcnt(6)
    v_mfma_f32_32x32x16_bf16 v[128:143], v[80:83], v[112:115], v[128:143]
    s_waitcnt lgkmcnt(4)
    v_mfma_f32_32x32x16_bf16 v[128:143], v[84:87], v[116:119], v[128:143]
    buffer_load_dwordx4 a[220:223], v3, s[16:19], s31 offen offset:3072 sc1
    s_add_u32 s31, s31, 4096
    s_waitcnt lgkmcnt(2)
    v_mfma_f32_32x32x16_bf16 v[128:143], v[88:91], v[120:123], v[128:143]
    s_waitcnt lgkmcnt(0)
    v_mfma_f32_32x32x16_bf16 v[128:143], v[92:95], v[124:127], v[128:143]
    s_mov_b64 exec, s[92:93]
    s_nop 10
    ds_write_b128 v232, v[128:131]
    s_mov_b64 exec, s[94:95]
    ds_write_b128 v233, v[132:135]
    s_mov_b64 exec, s[96:97]
    ds_write_b128 v234, v[136:139]
    s_mov_b64 exec, s[98:99]
    ds_write_b128 v235, v[140:143]
    s_mov_b64 exec, -1
    s_mul_i32 s33, s27, 5040
    s_add_u32 s33, s33, 131072
    s_add_u32 s4, s14, s33
    s_addc_u32 s5, s15, 0
    s_cmp_eq_u32 s27, 10
    s_movk_i32 s6, 5040
    s_cselect_b32 s6, 3360, s6
    s_mov_b32 s7, 0x20000
    s_waitcnt lgkmcnt(0)
    s_barrier
    buffer_load_dwordx4 a[224:227], v3, s[16:19], s31 offen offset:0 sc1
    ds_read_b32 v32, v239 offset:0
    ds_read_b32 v33, v239 offset:1024
    ds_read_b32 v34, v239 offset:2048
    ds_read_b32 v35, v239 offset:3072
    ds_read_b32 v36, v239 offset:4096
    s_waitcnt lgkmcnt(4)
    buffer_atomic_add_f32 v32, v238, s[4:7], 0 offen offset:0
    s_waitcnt lgkmcnt(3)
    buffer_atomic_add_f32 v33, v238, s[4:7], 0 offen offset:1024
    s_waitcnt lgkmcnt(2)
    buffer_atomic_add_f32 v34, v238, s[4:7], 0 offen offset:2048
    s_waitcnt lgkmcnt(1)
    buffer_atomic_add_f32 v35, v238, s[4:7], 0 offen offset:3072
    s_waitcnt lgkmcnt(0)
    v_add_u32 v238, 4096, v238
    buffer_atomic_add_f32 v36, v238, s[4:7], 0 offen offset:0
    buffer_load_dwordx4 a[228:231], v3, s[16:19], s31 offen offset:1024 sc1
    buffer_load_dwordx4 a[232:235], v3, s[16:19], s31 offen offset:2048 sc1
    buffer_load_dwordx4 a[236:239], v3, s[16:19], s31 offen offset:3072 sc1
    s_add_u32 s31, s31, 4096
    buffer_load_dwordx4 a[240:243], v3, s[16:19], s31 offen offset:0 sc1
    buffer_load_dwordx4 a[44:47], v3, s[16:19], s31 offen offset:1024 sc1
    buffer_load_dwordx4 a[48:51], v3, s[16:19], s31 offen offset:2048 sc1
    buffer_load_dwordx4 a[52:55], v3, s[16:19], s31 offen offset:3072 sc1
    s_add_u32 s31, s31, 4096
    buffer_load_dwordx4 a[56:59], v3, s[16:19], s31 offen offset:0 sc1
    buffer_load_dwordx4 a[60:63], v3, s[16:19], s31 offen offset:1024 sc1
    buffer_load_dwordx4 a[64:67], v3, s[16:19], s31 offen offset:2048 sc1
    buffer_load_dwordx4 a[68:71], v3, s[16:19], s31 offen offset:3072 sc1
    s_add_u32 s31, s31, 4096
    buffer_load_dwordx4 a[72:75], v3, s[16:19], s31 offen offset:0 sc1
    buffer_load_dwordx4 a[76:79], v3, s[16:19], s31 offen offset:1024 sc1
    buffer_load_dwordx4 a[80:83], v3, s[16:19], s31 offen offset:2048 sc1
    buffer_load_dwordx4 a[84:87], v3, s[16:19], s31 offen offset:3072 sc1
    s_add_u32 s31, s31, 4096
    buffer_load_dwordx4 a[88:91], v3, s[16:19], s31 offen offset:0 sc1
    buffer_load_dwordx4 a[92:95], v3, s[16:19], s31 offen offset:1024 sc1
    buffer_load_dwordx4 a[96:99], v3, s[16:19], s31 offen offset:2048 sc1
    buffer_load_dwordx4 a[100:103], v3, s[16:19], s31 offen offset:3072 sc1
    s_add_u32 s31, s31, 4096
    s_waitcnt vmcnt(19)
    s_branch p1_fin
p1_q:
    s_mul_i32 s33, s28, 40960
    s_sub_u32 s34, s27, 11
    s_lshl_b32 s34, s34, 13
    s_add_u32 s33, s33, s34
    s_add_u32 s33, s33, 11534336
    ds_read_b128 v[128:131], v3 offset:0
    ds_read_b128 v[132:135], v3 offset:1024
    ds_read_b128 v[136:139], v3 offset:2048
    ds_read_b128 v[140:143], v3 offset:3072
    ds_read_b128 v[144:147], v3 offset:4096
    ds_read_b128 v[148:151], v3 offset:5120
    ds_read_b128 v[152:155], v3 offset:6144
    ds_read_b128 v[156:159], v3 offset:7168
    s_waitcnt vmcnt(11) lgkmcnt(4)
    v_mfma_f32_32x32x16_bf16 v[64:79], v[128:131], a[0:3], 0
    s_add_u32 m0, s23, 32768
    s_nop 0
    buffer_load_dwordx4 v3, s[16:19], s22 offen offset:0 sc1 lds
    v_mfma_f32_32x32x16_bf16 v[80:95], v[132:135], a[0:3], 0
    ds_read_b128 v[160:163], v3 offset:8192
    ds_read_b128 v[164:167], v3 offset:9216
    v_mfma_f32_32x32x16_bf16 v[96:111], v[136:139], a[0:3], 0
    buffer_load_dwordx4 v3, s[16:19], s22 offen offset:1024 sc1 lds
    v_mfma_f32_32x32x16_bf16 v[112:127], v[140:143], a[0:3], 0
    ds_read_b128 v[168:171], v3 offset:10240
    ds_read_b128 v[172:175], v3 offset:11264
    s_waitcnt vmcnt(12) lgkmcnt(4)
    v_mfma_f32_32x32x16_bf16 v[64:79], v[144:147], a[4:7], v[64:79]
    buffer_load_dwordx4 v3, s[16:19], s22 offen offset:2048 sc1 lds
    v_mfma_f32_32x32x16_bf16 v[80:95], v[148:151], a[4:7], v[80:95]
    ds_read_b128 v[128:131], v3 offset:12288
    ds_read_b128 v[132:135], v3 offset:13312
    v_mfma_f32_32x32x16_bf16 v[96:111], v[152:155], a[4:7], v[96:111]
    buffer_load_dwordx4 v3, s[16:19], s22 offen offset:3072 sc1 lds
    s_add_u32 s22, s22, 16384
    v_mfma_f32_32x32x16_bf16 v[112:127], v[156:159], a[4:7], v[112:127]
    ds_read_b128 v[136:139], v3 offset:14336
    ds_read_b128 v[140:143], v3 offset:15360
    s_waitcnt vmcnt(13) lgkmcnt(4)
    v_mfma_f32_32x32x16_bf16 v[64:79], v[160:163], a[8:11], v[64:79]
    buffer_load_dwordx4 a[32:35], v3, s[16:19], s21 offen offset:0 sc1
    v_mfma_f32_32x32x16_bf16 v[80:95], v[164:167], a[8:11], v[80:95]
    s_waitcnt vmcnt(9)
    s_barrier
    ds_read_b128 v[144:147], v3 offset:16384
    ds_read_b128 v[148:151], v3 offset:17408
    v_mfma_f32_32x32x16_bf16 v[96:111], v[168:171], a[8:11], v[96:111]
    buffer_load_dwordx4 a[36:39], v3, s[16:19], s21 offen offset:1024 sc1
    v_mfma_f32_32x32x16_bf16 v[112:127], v[172:175], a[8:11], v[112:127]
    ds_read_b128 v[152:155], v3 offset:18432
    ds_read_b128 v[156:159], v3 offset:19456
    s_waitcnt lgkmcnt(4)
    v_mfma_f32_32x32x16_bf16 v[64:79], v[128:131], a[12:15], v[64:79]
    buffer_load_dwordx4 a[40:43], v3, s[16:19], s21 offen offset:2048 sc1
    v_mfma_f32_32x32x16_bf16 v[80:95], v[132:135], a[12:15], v[80:95]
    ds_read_b128 v[160:163], v3 offset:20480
    ds_read_b128 v[164:167], v3 offset:21504
    v_mfma_f32_32x32x16_bf16 v[96:111], v[136:139], a[12:15], v[96:111]
    buffer_load_dwordx4 a[44:47], v3, s[16:19], s21 offen offset:3072 sc1
    s_add_u32 s21, s21, 4096
    v_mfma_f32_32x32x16_bf16 v[112:127], v[140:143], a[12:15], v[112:127]
    ds_read_b128 v[168:171], v3 offset:22528
    ds_read_b128 v[172:175], v3 offset:23552
    s_waitcnt vmcnt(11) lgkmcnt(4)
    v_mfma_f32_32x32x16_bf16 v[64:79], v[144:147], a[16:19], v[64:79]
    s_add_u32 m0, s23, 49152
    s_nop 0
    buffer_load_dwordx4 v3, s[16:19], s22 offen offset:0 sc1 lds
    v_mfma_f32_32x32x16_bf16 v[80:95], v[148:151], a[16:19], v[80:95]
    ds_read_b128 v[128:131], v3 offset:24576
    ds_read_b128 v[132:135], v3 offset:25600
    v_mfma_f32_32x32x16_bf16 v[96:111], v[152:155], a[16:19], v[96:111]
    buffer_load_dwordx4 v3, s[16:19], s22 offen offset:1024 sc1 lds
    v_mfma_f32_32x32x16_bf16 v[112:127], v[156:159], a[16:19], v[112:127]
    ds_read_b128 v[136:139], v3 offset:26624
    ds_read_b128 v[140:143], v3 offset:27648
    s_waitcnt vmcnt(12) lgkmcnt(4)
    v_mfma_f32_32x32x16_bf16 v[64:79], v[160:163], a[20:23], v[64:79]
    buffer_load_dwordx4 v3, s[16:19], s22 offen offset:2048 sc1 lds
    v_mfma_f32_32x32x16_bf16 v[80:95], v[164:167], a[20:23], v[80:95]
    ds_read_b128 v[144:147], v3 offset:28672
    ds_read_b128 v[148:151], v3 offset:29696
    v_mfma_f32_32x32x16_bf16 v[96:111], v[168:171], a[20:23], v[96:111]
    buffer_load_dwordx4 v3, s[16:19], s22 offen offset:3072 sc1 lds
    s_add_u32 s22, s22, 16384
    v_mfma_f32_32x32x16_bf16 v[112:127], v[172:175], a[20:23], v[112:127]
    ds_read_b128 v[152:155], v3 offset:30720
    ds_read_b128 v[156:159], v3 offset:31744
    s_waitcnt vmcnt(13) lgkmcnt(4)
    v_mfma_f32_32x32x16_bf16 v[64:79], v[128:131], a[24:27], v[64:79]
    buffer_load_dwordx4 a[48:51], v3, s[16:19], s21 offen offset:0 sc1
    v_mfma_f32_32x32x16_bf16 v[80:95], v[132:135], a[24:27], v[80:95]
    s_waitcnt vmcnt(9)
    s_barrier
    ds_read_b128 v[160:163], v3 offset:32768
    ds_read_b128 v[164:167], v3 offset:33792
    v_mfma_f32_32x32x16_bf16 v[96:111], v[136:139], a[24:27], v[96:111]
    buffer_load_dwordx4 a[52:55], v3, s[16:19], s21 offen offset:1024 sc1
    v_mfma_f32_32x32x16_bf16 v[112:127], v[140:143], a[24:27], v[112:127]
    ds_read_b128 v[168:171], v3 offset:34816
    ds_read_b128 v[172:175], v3 offset:35840
    s_waitcnt lgkmcnt(4)
    v_mfma_f32_32x32x16_bf16 v[64:79], v[144:147], a[28:31], v[64:79]
    buffer_load_dwordx4 a[56:59], v3, s[16:19], s21 offen offset:2048 sc1
    v_mfma_f32_32x32x16_bf16 v[80:95], v[148:151], a[28:31], v[80:95]
    ds_read_b128 v[128:131], v3 offset:36864
    ds_read_b128 v[132:135], v3 offset:37888
    v_mfma_f32_32x32x16_bf16 v[96:111], v[152:155], a[28:31], v[96:111]
    buffer_load_dwordx4 a[60:63], v3, s[16:19], s21 offen offset:3072 sc1
    s_add_u32 s21, s21, 4096
    v_mfma_f32_32x32x16_bf16 v[112:127], v[156:159], a[28:31], v[112:127]
    ds_read_b128 v[136:139], v3 offset:38912
    ds_read_b128 v[140:143], v3 offset:39936
    s_waitcnt vmcnt(11) lgkmcnt(4)
    v_mfma_f32_32x32x16_bf16 v[64:79], v[160:163], a[32:35], v[64:79]
    s_add_u32 m0, s23, 65536
    s_nop 0
    buffer_load_dwordx4 v3, s[16:19], s22 offen offset:0 sc1 lds
    v_mfma_f32_32x32x16_bf16 v[80:95], v[164:167], a[32:35], v[80:95]
    ds_read_b128 v[144:147], v3 offset:40960
    ds_read_b128 v[148:151], v3 offset:41984
    v_mfma_f32_32x32x16_bf16 v[96:111], v[168:171], a[32:35], v[96:111]
    buffer_load_dwordx4 v3, s[16:19], s22 offen offset:1024 sc1 lds
    v_mfma_f32_32x32x16_bf16 v[112:127], v[172:175], a[32:35], v[112:127]
    ds_read_b128 v[152:155], v3 offset:43008
    ds_read_b128 v[156:159], v3 offset:44032
    s_waitcnt vmcnt(12) lgkmcnt(4)
    v_mfma_f32_32x32x16_bf16 v[64:79], v[128:131], a[36:39], v[64:79]
    buffer_load_dwordx4 v3, s[16:19], s22 offen offset:2048 sc1 lds
    v_mfma_f32_32x32x16_bf16 v[80:95], v[132:135], a[36:39], v[80:95]
    ds_read_b128 v[160:163], v3 offset:45056
    ds_read_b128 v[164:167], v3 offset:46080
    v_mfma_f32_32x32x16_bf16 v[96:111], v[136:139], a[36:39], v[96:111]
    buffer_load_dwordx4 v3, s[16:19], s22 offen offset:3072 sc1 lds
    s_add_u32 s22, s22, 16384
    v_mfma_f32_32x32x16_bf16 v[112:127], v[140:143], a[36:39], v[112:127]
    ds_read_b128 v[168:171], v3 offset:47104
    ds_read_b128 v[172:175], v3 offset:48128
    s_waitcnt vmcnt(13) lgkmcnt(4)
    v_mfma_f32_32x32x16_bf16 v[64:79], v[144:147], a[40:43], v[64:79]
    buffer_load_dwordx4 a[64:67], v3, s[16:19], s21 offen offset:0 sc1
    v_mfma_f32_32x32x16_bf16 v[80:95], v[148:151], a[40:43], v[80:95]
    s_waitcnt vmcnt(9)
    s_barrier
    s_cmp_lg_u32 s20, 1
    s_cbranch_scc1 sig3
    v_mov_b32 v7, 0
    s_lshl_b32 s42, s45, 2
    s_add_u32 s42, s42, 4096
    v_mov_b32 v6, s44
    s_mov_b64 exec, 1
    buffer_store_dword v6, v7, s[16:19], s42 offen sc1
    s_mov_b64 exec, -1
sig3:
    ds_read_b128 v[128:131], v3 offset:49152
    ds_read_b128 v[132:135], v3 offset:50176
    v_mfma_f32_32x32x16_bf16 v[96:111], v[152:155], a[40:43], v[96:111]
    buffer_load_dwordx4 a[68:71], v3, s[16:19], s21 offen offset:1024 sc1
    v_mfma_f32_32x32x16_bf16 v[112:127], v[156:159], a[40:43], v[112:127]
    ds_read_b128 v[136:139], v3 offset:51200
    ds_read_b128 v[140:143], v3 offset:52224
    s_waitcnt lgkmcnt(4)
    v_mfma_f32_32x32x16_bf16 v[64:79], v[160:163], a[44:47], v[64:79]
    buffer_load_dwordx4 a[72:75], v3, s[16:19], s21 offen offset:2048 sc1
    v_mfma_f32_32x32x16_bf16 v[80:95], v[164:167], a[44:47], v[80:95]
    ds_read_b128 v[144:147], v3 offset:53248
    ds_read_b128 v[148:151], v3 offset:54272
    v_mfma_f32_32x32x16_bf16 v[96:111], v[168:171], a[44:47], v[96:111]
    buffer_load_dwordx4 a[76:79], v3, s[16:19], s21 offen offset:3072 sc1
    s_add_u32 s21, s21, 4096
    v_mfma_f32_32x32x16_bf16 v[112:127], v[172:175], a[44:47], v[112:127]
    ds_read_b128 v[152:155], v3 offset:55296
    ds_read_b128 v[156:159], v3 offset:56320
    s_waitcnt vmcnt(11) lgkmcnt(4)
    v_mfma_f32_32x32x16_bf16 v[64:79], v[128:131], a[48:51], v[64:79]
    s_add_u32 m0, s23, 81920
    s_nop 0
    buffer_load_dwordx4 v3, s[16:19], s22 offen offset:0 sc1 lds
    v_mfma_f32_32x32x16_bf16 v[80:95], v[132:135], a[48:51], v[80:95]
    ds_read_b128 v[160:163], v3 offset:57344
    ds_read_b128 v[164:167], v3 offset:58368
    v_mfma_f32_32x32x16_bf16 v[96:111], v[136:139], a[48:51], v[96:111]
    buffer_load_dwordx4 v3, s[16:19], s22 offen offset:1024 sc1 lds
    v_mfma_f32_32x32x16_bf16 v[112:127], v[140:143], a[48:51], v[112:127]
    ds_read_b128 v[168:171], v3 offset:59392
    ds_read_b128 v[172:175], v3 offset:60416
    s_waitcnt vmcnt(12) lgkmcnt(4)
    v_mfma_f32_32x32x16_bf16 v[64:79], v[144:147], a[52:55], v[64:79]
    buffer_load_dwordx4 v3, s[16:19], s22 offen offset:2048 sc1 lds
    v_mfma_f32_32x32x16_bf16 v[80:95], v[148:151], a[52:55], v[80:95]
    ds_read_b128 v[128:131], v3 offset:61440
    ds_read_b128 v[132:135], v3 offset:62464
    v_mfma_f32_32x32x16_bf16 v[96:111], v[152:155], a[52:55], v[96:111]
    buffer_load_dwordx4 v3, s[16:19], s22 offen offset:3072 sc1 lds
    s_add_u32 s22, s22, 16384
    v_mfma_f32_32x32x16_bf16 v[112:127], v[156:159], a[52:55], v[112:127]
    ds_read_b128 v[136:139], v3 offset:63488
    ds_read_b128 v[140:143], v3 offset:64512
    s_waitcnt vmcnt(13) lgkmcnt(4)
    v_mfma_f32_32x32x16_bf16 v[64:79], v[160:163], a[56:59], v[64:79]
    buffer_load_dwordx4 a[80:83], v3, s[16:19], s21 offen offset:0 sc1
    v_mfma_f32_32x32x16_bf16 v[80:95], v[164:167], a[56:59], v[80:95]
    s_waitcnt vmcnt(9)
    s_barrier
    ds_read_b128 v[144:147], v4 offset:0
    ds_read_b128 v[148:151], v4 offset:1024
    v_mfma_f32_32x32x16_bf16 v[96:111], v[168:171], a[56:59], v[96:111]
    buffer_load_dwordx4 a[84:87], v3, s[16:19], s21 offen offset:1024 sc1
    v_mfma_f32_32x32x16_bf16 v[112:127], v[172:175], a[56:59], v[112:127]
    ds_read_b128 v[152:155], v4 offset:2048
    ds_read_b128 v[156:159], v4 offset:3072
    s_waitcnt lgkmcnt(4)
    v_mfma_f32_32x32x16_bf16 v[64:79], v[128:131], a[60:63], v[64:79]
    buffer_load_dwordx4 a[88:91], v3, s[16:19], s21 offen offset:2048 sc1
    v_mfma_f32_32x32x16_bf16 v[80:95], v[132:135], a[60:63], v[80:95]
    ds_read_b128 v[160:163], v4 offset:4096
    ds_read_b128 v[164:167], v4 offset:5120
    v_mfma_f32_32x32x16_bf16 v[96:111], v[136:139], a[60:63], v[96:111]
    buffer_load_dwordx4 a[92:95], v3, s[16:19], s21 offen offset:3072 sc1
    s_add_u32 s21, s21, 4096
    v_mfma_f32_32x32x16_bf16 v[112:127], v[140:143], a[60:63], v[112:127]
    ds_read_b128 v[168:171], v4 offset:6144
    ds_read_b128 v[172:175], v4 offset:7168
    s_waitcnt vmcnt(11) lgkmcnt(4)
    v_mfma_f32_32x32x16_bf16 v[64:79], v[144:147], a[64:67], v[64:79]
    s_add_u32 m0, s23, 98304
    s_nop 0
    buffer_load_dwordx4 v3, s[16:19], s22 offen offset:0 sc1 lds
    v_mfma_f32_32x32x16_bf16 v[80:95], v[148:151], a[64:67], v[80:95]
    ds_read_b128 v[128:131], v4 offset:8192
    ds_read_b128 v[132:135], v4 offset:9216
    v_mfma_f32_32x32x16_bf16 v[96:111], v[152:155], a[64:67], v[96:111]
    buffer_load_dwordx4 v3, s[16:19], s22 offen offset:1024 sc1 lds
    v_mfma_f32_32x32x16_bf16 v[112:127], v[156:159], a[64:67], v[112:127]
    ds_read_b128 v[136:139], v4 offset:10240
    ds_read_b128 v[140:143], v4 offset:11264
    s_waitcnt vmcnt(12) lgkmcnt(4)
    v_mfma_f32_32x32x16_bf16 v[64:79], v[160:163], a[68:71], v[64:79]
    buffer_load_dwordx4 v3, s[16:19], s22 offen offset:2048 sc1 lds
    v_mfma_f32_32x32x16_bf16 v[80:95], v[164:167], a[68:71], v[80:95]
    ds_read_b128 v[144:147], v4 offset:12288
    ds_read_b128 v[148:151], v4 offset:13312
    v_mfma_f32_32x32x16_bf16 v[96:111], v[168:171], a[68:71], v[96:111]
    buffer_load_dwordx4 v3, s[16:19], s22 offen offset:3072 sc1 lds
    s_add_u32 s22, s22, 16384
    v_mfma_f32_32x32x16_bf16 v[112:127], v[172:175], a[68:71], v[112:127]
    ds_read_b128 v[152:155], v4 offset:14336
    ds_read_b128 v[156:159], v4 offset:15360
    s_waitcnt vmcnt(13) lgkmcnt(4)
    v_mfma_f32_32x32x16_bf16 v[64:79], v[128:131], a[72:75], v[64:79]
    buffer_load_dwordx4 a[96:99], v3, s[16:19], s21 offen offset:0 sc1
    v_mfma_f32_32x32x16_bf16 v[80:95], v[132:135], a[72:75], v[80:95]
    s_waitcnt vmcnt(9)
    s_barrier
    ds_read_b128 v[160:163], v4 offset:16384
    ds_read_b128 v[164:167], v4 offset:17408
    v_mfma_f32_32x32x16_bf16 v[96:111], v[136:139], a[72:75], v[96:111]
    buffer_load_dwordx4 a[100:103], v3, s[16:19], s21 offen offset:1024 sc1
    v_mfma_f32_32x32x16_bf16 v[112:127], v[140:143], a[72:75], v[112:127]
    ds_read_b128 v[168:171], v4 offset:18432
    ds_read_b128 v[172:175], v4 offset:19456
    s_waitcnt lgkmcnt(4)
    v_mfma_f32_32x32x16_bf16 v[64:79], v[144:147], a[76:79], v[64:79]
    buffer_load_dwordx4 a[104:107], v3, s[16:19], s21 offen offset:2048 sc1
    v_mfma_f32_32x32x16_bf16 v[80:95], v[148:151], a[76:79], v[80:95]
    ds_read_b128 v[128:131], v4 offset:20480
    ds_read_b128 v[132:135], v4 offset:21504
    v_mfma_f32_32x32x16_bf16 v[96:111], v[152:155], a[76:79], v[96:111]
    buffer_load_dwordx4 a[108:111], v3, s[16:19], s21 offen offset:3072 sc1
    s_add_u32 s21, s21, 4096
    v_mfma_f32_32x32x16_bf16 v[112:127], v[156:159], a[76:79], v[112:127]
    ds_read_b128 v[136:139], v4 offset:22528
    ds_read_b128 v[140:143], v4 offset:23552
    s_waitcnt vmcnt(11) lgkmcnt(4)
    v_mfma_f32_32x32x16_bf16 v[64:79], v[160:163], a[80:83], v[64:79]
    s_add_u32 m0, s23, 114688
    s_nop 0
    buffer_load_dwordx4 v3, s[16:19], s22 offen offset:0 sc1 lds
    v_mfma_f32_32x32x16_bf16 v[80:95], v[164:167], a[80:83], v[80:95]
    ds_read_b128 v[144:147], v4 offset:24576
    ds_read_b128 v[148:151], v4 offset:25600
    v_mfma_f32_32x32x16_bf16 v[96:111], v[168:171], a[80:83], v[96:111]
    buffer_load_dwordx4 v3, s[16:19], s22 offen offset:1024 sc1 lds
    v_mfma_f32_32x32x16_bf16 v[112:127], v[172:175], a[80:83], v[112:127]
    ds_read_b128 v[152:155], v4 offset:26624
    ds_read_b128 v[156:159], v4 offset:27648
    s_waitcnt vmcnt(12) lgkmcnt(4)
    v_mfma_f32_32x32x16_bf16 v[64:79], v[128:131], a[84:87], v[64:79]
    buffer_load_dwordx4 v3, s[16:19], s22 offen offset:2048 sc1 lds
    v_mfma_f32_32x32x16_bf16 v[80:95], v[132:135], a[84:87], v[80:95]
    ds_read_b128 v[160:163], v4 offset:28672
    ds_read_b128 v[164:167], v4 offset:29696
    v_mfma_f32_32x32x16_bf16 v[96:111], v[136:139], a[84:87], v[96:111]
    buffer_load_dwordx4 v3, s[16:19], s22 offen offset:3072 sc1 lds
    s_add_u32 s22, s22, 16384
    v_mfma_f32_32x32x16_bf16 v[112:127], v[140:143], a[84:87], v[112:127]
    ds_read_b128 v[168:171], v4 offset:30720
    ds_read_b128 v[172:175], v4 offset:31744
    s_waitcnt vmcnt(13) lgkmcnt(4)
    v_mfma_f32_32x32x16_bf16 v[64:79], v[144:147], a[88:91], v[64:79]
    buffer_load_dwordx4 a[112:115], v3, s[16:19], s21 offen offset:0 sc1
    v_mfma_f32_32x32x16_bf16 v[80:95], v[148:151], a[88:91], v[80:95]
    s_waitcnt vmcnt(9)
    s_barrier
    ds_read_b128 v[128:131], v4 offset:32768
    ds_read_b128 v[132:135], v4 offset:33792
    v_mfma_f32_32x32x16_bf16 v[96:111], v[152:155], a[88:91], v[96:111]
    buffer_load_dwordx4 a[116:119], v3, s[16:19], s21 offen offset:1024 sc1
    v_mfma_f32_32x32x16_bf16 v[112:127], v[156:159], a[88:91], v[112:127]
    ds_read_b128 v[136:139], v4 offset:34816
    ds_read_b128 v[140:143], v4 offset:35840
    s_waitcnt lgkmcnt(4)
    v_mfma_f32_32x32x16_bf16 v[64:79], v[160:163], a[92:95], v[64:79]
    buffer_load_dwordx4 a[120:123], v3, s[16:19], s21 offen offset:2048 sc1
    v_mfma_f32_32x32x16_bf16 v[80:95], v[164:167], a[92:95], v[80:95]
    ds_read_b128 v[144:147], v4 offset:36864
    ds_read_b128 v[148:151], v4 offset:37888
    v_mfma_f32_32x32x16_bf16 v[96:111], v[168:171], a[92:95], v[96:111]
    buffer_load_dwordx4 a[124:127], v3, s[16:19], s21 offen offset:3072 sc1
    s_add_u32 s21, s21, 4096
    v_mfma_f32_32x32x16_bf16 v[112:127], v[172:175], a[92:95], v[112:127]
    ds_read_b128 v[152:155], v4 offset:38912
    ds_read_b128 v[156:159], v4 offset:39936
    s_waitcnt vmcnt(11) lgkmcnt(4)
    v_mfma_f32_32x32x16_bf16 v[64:79], v[128:131], a[96:99], v[64:79]
    s_add_u32 m0, s23, 0
    s_nop 0
    buffer_load_dwordx4 v3, s[16:19], s22 offen offset:0 sc1 lds
    v_mfma_f32_32x32x16_bf16 v[80:95], v[132:135], a[96:99], v[80:95]
    ds_read_b128 v[160:163], v4 offset:40960
    ds_read_b128 v[164:167], v4 offset:41984
    v_mfma_f32_32x32x16_bf16 v[96:111], v[136:139], a[96:99], v[96:111]
    buffer_load_dwordx4 v3, s[16:19], s22 offen offset:1024 sc1 lds
    v_mfma_f32_32x32x16_bf16 v[112:127], v[140:143], a[96:99], v[112:127]
    ds_read_b128 v[168:171], v4 offset:43008
    ds_read_b128 v[172:175], v4 offset:44032
    s_waitcnt vmcnt(12) lgkmcnt(4)
    v_mfma_f32_32x32x16_bf16 v[64:79], v[144:147], a[100:103], v[64:79]
    buffer_load_dwordx4 v3, s[16:19], s22 offen offset:2048 sc1 lds
    v_mfma_f32_32x32x16_bf16 v[80:95], v[148:151], a[100:103], v[80:95]
    ds_read_b128 v[128:131], v4 offset:45056
    ds_read_b128 v[132:135], v4 offset:46080
    v_mfma_f32_32x32x16_bf16 v[96:111], v[152:155], a[100:103], v[96:111]
    buffer_load_dwordx4 v3, s[16:19], s22 offen offset:3072 sc1 lds
    s_add_u32 s22, s22, 16384
    v_mfma_f32_32x32x16_bf16 v[112:127], v[156:159], a[100:103], v[112:127]
    ds_read_b128 v[136:139], v4 offset:47104
    ds_read_b128 v[140:143], v4 offset:48128
    s_waitcnt vmcnt(13) lgkmcnt(4)
    v_mfma_f32_32x32x16_bf16 v[64:79], v[160:163], a[104:107], v[64:79]
    buffer_load_dwordx4 a[128:131], v3, s[16:19], s21 offen offset:0 sc1
    v_mfma_f32_32x32x16_bf16 v[80:95], v[164:167], a[104:107], v[80:95]
    s_waitcnt vmcnt(9)
    s_barrier
    ds_read_b128 v[144:147], v4 offset:49152
    ds_read_b128 v[148:151], v4 offset:50176
    v_mfma_f32_32x32x16_bf16 v[96:111], v[168:171], a[104:107], v[96:111]
    buffer_load_dwordx4 a[132:135], v3, s[16:19], s21 offen offset:1024 sc1
    v_mfma_f32_32x32x16_bf16 v[112:127], v[172:175], a[104:107], v[112:127]
    ds_read_b128 v[152:155], v4 offset:51200
    ds_read_b128 v[156:159], v4 offset:52224
    s_waitcnt lgkmcnt(4)
    v_mfma_f32_32x32x16_bf16 v[64:79], v[128:131], a[108:111], v[64:79]
    buffer_load_dwordx4 a[136:139], v3, s[16:19], s21 offen offset:2048 sc1
    v_mfma_f32_32x32x16_bf16 v[80:95], v[132:135], a[108:111], v[80:95]
    ds_read_b128 v[160:163], v4 offset:53248
    ds_read_b128 v[164:167], v4 offset:54272
    v_mfma_f32_32x32x16_bf16 v[96:111], v[136:139], a[108:111], v[96:111]
    buffer_load_dwordx4 a[140:143], v3, s[16:19], s21 offen offset:3072 sc1
    s_add_u32 s21, s21, 4096
    v_mfma_f32_32x32x16_bf16 v[112:127], v[140:143], a[108:111], v[112:127]
    ds_read_b128 v[168:171], v4 offset:55296
    ds_read_b128 v[172:175], v4 offset:56320
    s_waitcnt vmcnt(11) lgkmcnt(4)
    v_mfma_f32_32x32x16_bf16 v[64:79], v[144:147], a[112:115], v[64:79]
    s_add_u32 m0, s23, 16384
    s_nop 0
    buffer_load_dwordx4 v3, s[16:19], s22 offen offset:0 sc1 lds
    s_mov_b32 s42, 4096
    buffer_load_dwordx4 v[20:23], v3, s[16:19], s42 offen sc1
    v_mfma_f32_32x32x16_bf16 v[80:95], v[148:151], a[112:115], v[80:95]
    ds_read_b128 v[128:131], v4 offset:57344
    ds_read_b128 v[132:135], v4 offset:58368
    v_mfma_f32_32x32x16_bf16 v[96:111], v[152:155], a[112:115], v[96:111]
    buffer_load_dwordx4 v3, s[16:19], s22 offen offset:1024 sc1 lds
    v_mfma_f32_32x32x16_bf16 v[112:127], v[156:159], a[112:115], v[112:127]
    ds_read_b128 v[136:139], v4 offset:59392
    ds_read_b128 v[140:143], v4 offset:60416
    s_waitcnt vmcnt(13) lgkmcnt(4)
    v_mfma_f32_32x32x16_bf16 v[64:79], v[160:163], a[116:119], v[64:79]
    buffer_load_dwordx4 v3, s[16:19], s22 offen offset:2048 sc1 lds
    v_mfma_f32_32x32x16_bf16 v[80:95], v[164:167], a[116:119], v[80:95]
    ds_read_b128 v[144:147], v4 offset:61440
    ds_read_b128 v[148:151], v4 offset:62464
    v_mfma_f32_32x32x16_bf16 v[96:111], v[168:171], a[116:119], v[96:111]
    buffer_load_dwordx4 v3, s[16:19], s22 offen offset:3072 sc1 lds
    s_add_u32 s22, s22, 16384
    v_mfma_f32_32x32x16_bf16 v[112:127], v[172:175], a[116:119], v[112:127]
    ds_read_b128 v[152:155], v4 offset:63488
    ds_read_b128 v[156:159], v4 offset:64512
    s_waitcnt vmcnt(14) lgkmcnt(4)
    v_mfma_f32_32x32x16_bf16 v[64:79], v[128:131], a[120:123], v[64:79]
    buffer_load_dwordx4 a[144:147], v3, s[16:19], s21 offen offset:0 sc1
    v_mfma_f32_32x32x16_bf16 v[80:95], v[132:135], a[120:123], v[80:95]
    s_waitcnt vmcnt(10)
    s_barrier
    ds_read_b128 v[160:163], v3 offset:0
    ds_read_b128 v[164:167], v3 offset:1024
    v_mfma_f32_32x32x16_bf16 v[96:111], v[136:139], a[120:123], v[96:111]
    buffer_load_dwordx4 a[148:151], v3, s[16:19], s21 offen offset:1024 sc1
    v_mfma_f32_32x32x16_bf16 v[112:127], v[140:143], a[120:123], v[112:127]
    ds_read_b128 v[168:171], v3 offset:2048
    ds_read_b128 v[172:175], v3 offset:3072
    s_waitcnt lgkmcnt(4)
    v_mfma_f32_32x32x16_bf16 v[64:79], v[144:147], a[124:127], v[64:79]
    buffer_load_dwordx4 a[152:155], v3, s[16:19], s21 offen offset:2048 sc1
    ds_read_b64_tr_b16 v[32:33], v52
    ds_read_b64_tr_b16 v[34:35], v57
    ds_read_b64_tr_b16 v[36:37], v53
    ds_read_b64_tr_b16 v[38:39], v58
    ds_read_b64_tr_b16 v[40:41], v54
    ds_read_b64_tr_b16 v[42:43], v59
    v_mfma_f32_32x32x16_bf16 v[80:95], v[148:151], a[124:127], v[80:95]
    ds_read_b128 v[128:131], v3 offset:4096
    ds_read_b128 v[132:135], v3 offset:8192
    ds_read_b64_tr_b16 v[44:45], v55
    ds_read_b64_tr_b16 v[46:47], v60
    ds_read_b64_tr_b16 v[48:49], v56
    ds_read_b64_tr_b16 v[50:51], v61
    v_mfma_f32_32x32x16_bf16 v[96:111], v[152:155], a[124:127], v[96:111]
    buffer_load_dwordx4 a[156:159], v3, s[16:19], s21 offen offset:3072 sc1
    s_add_u32 s21, s21, 4096
    v_mfma_f32_32x32x16_bf16 v[112:127], v[156:159], a[124:127], v[112:127]
    ds_read_b128 v[136:139], v3 offset:12288
    s_waitcnt vmcnt(4)
    s_barrier
    ds_read_b128 v[140:143], v3 offset:16384
    s_waitcnt lgkmcnt(14)
    v_mfma_f32_32x32x16_bf16 v[64:79], v[160:163], a[128:131], v[64:79]
    v_xor_b32 v20, s44, v20
    v_xor_b32 v21, s44, v21
    v_xor_b32 v22, s44, v22
    v_xor_b32 v23, s44, v23
    v_or3_b32 v20, v20, v21, v22
    v_or_b32 v20, v20, v23
    v_cmp_ne_u32 vcc, 0, v20
    s_cbranch_vccz p1_okq
    s_mov_b32 s42, 4096
    s_mov_b32 s43, 0x20000
poll3:
    buffer_load_dwordx4 v[20:23], v3, s[16:19], s42 offen sc1
    s_waitcnt vmcnt(0)
    v_xor_b32 v20, s44, v20
    v_xor_b32 v21, s44, v21
    v_xor_b32 v22, s44, v22
    v_xor_b32 v23, s44, v23
    v_or3_b32 v20, v20, v21, v22
    v_or_b32 v20, v20, v23
    v_cmp_ne_u32 vcc, 0, v20
    s_cbranch_vccz poll3d
    s_sleep 8
    s_sub_u32 s43, s43, 1
    s_cbranch_scc0 poll3
poll3d:
p1_okq:
    v_mfma_f32_32x32x16_bf16 v[80:95], v[164:167], a[128:131], v[80:95]
    ds_read_b128 v[144:147], v3 offset:20480
    ds_read_b128 v[148:151], v3 offset:24576
    v_mfma_f32_32x32x16_bf16 v[96:111], v[168:171], a[128:131], v[96:111]
    v_mov_b32 v63, 0
    s_mov_b32 s6, 0x3f803f80
    s_waitcnt lgkmcnt(14)
    buffer_store_dwordx4 v[32:35], v3, s[8:11], s24 offen sc1
    s_add_u32 s24, s24, s25
    v_dot2_f32_bf16 v63, v32, s6, v63
    v_dot2_f32_bf16 v63, v33, s6, v63
    v_dot2_f32_bf16 v63, v34, s6, v63
    v_mfma_f32_32x32x16_bf16 v[112:127], v[172:175], a[128:131], v[112:127]
    ds_read_b128 v[152:155], v3 offset:28672
    ds_read_b128 v[156:159], v3 offset:5120
    v_dot2_f32_bf16 v63, v35, s6, v63
    s_waitcnt lgkmcnt(14)
    buffer_store_dwordx4 v[36:39], v3, s[8:11], s24 offen sc1
    s_add_u32 s24, s24, s25
    v_dot2_f32_bf16 v63, v36, s6, v63
    v_dot2_f32_bf16 v63, v37, s6, v63
    v_dot2_f32_bf16 v63, v38, s6, v63
    v_dot2_f32_bf16 v63, v39, s6, v63
    s_waitcnt vmcnt(5) lgkmcnt(4)
    v_mfma_f32_32x32x16_bf16 v[64:79], v[128:131], a[132:135], v[64:79]
    buffer_store_dwordx4 v[40:43], v3, s[8:11], s24 offen sc1
    s_add_u32 s24, s24, s25
    v_dot2_f32_bf16 v63, v40, s6, v63
    v_dot2_f32_bf16 v63, v41, s6, v63
    v_dot2_f32_bf16 v63, v42, s6, v63
    v_dot2_f32_bf16 v63, v43, s6, v63
    buffer_store_dwordx4 v[44:47], v3, s[8:11], s24 offen sc1
    s_add_u32 s24, s24, s25
    v_mfma_f32_32x32x16_bf16 v[64:79], v[132:135], a[136:139], v[64:79]
    ds_read_b128 v[160:163], v3 offset:9216
    ds_read_b128 v[164:167], v3 offset:13312
    v_dot2_f32_bf16 v63, v44, s6, v63
    v_dot2_f32_bf16 v63, v45, s6, v63
    v_dot2_f32_bf16 v63, v46, s6, v63
    v_dot2_f32_bf16 v63, v47, s6, v63
    buffer_store_dwordx4 v[48:51], v3, s[8:11], s24 offen sc1
    s_add_u32 s24, s24, s25
    v_dot2_f32_bf16 v63, v48, s6, v63
    v_mfma_f32_32x32x16_bf16 v[64:79], v[136:139], a[140:143], v[64:79]
    v_dot2_f32_bf16 v63, v49, s6, v63
    v_dot2_f32_bf16 v63, v50, s6, v63
    v_dot2_f32_bf16 v63, v51, s6, v63
    s_nop 2
    v_mov_b32 v52, v63
    s_nop 0
    s_nop 0
    v_permlane32_swap_b32 v63, v52
    v_add_f32 v63, v63, v52
    v_mfma_f32_32x32x16_bf16 v[64:79], v[140:143], a[144:147], v[64:79]
    ds_read_b128 v[168:171], v3 offset:17408
    ds_read_b128 v[172:175], v3 offset:21504
    buffer_store_dword v63, v62, s[8:11], s37 offen sc1
    s_waitcnt vmcnt(6) lgkmcnt(4)
    v_mfma_f32_32x32x16_bf16 v[64:79], v[144:147], a[148:151], v[64:79]
    v_mfma_f32_32x32x16_bf16 v[64:79], v[148:151], a[152:155], v[64:79]
    ds_read_b128 v[128:131], v3 offset:25600
    ds_read_b128 v[132:135], v3 offset:29696
    v_mfma_f32_32x32x16_bf16 v[64:79], v[152:155], a[156:159], v[64:79]
    buffer_load_dwordx4 a[160:163], v3, s[16:19], s31 offen offset:0 sc1
    v_mfma_f32_32x32x16_bf16 v[80:95], v[156:159], a[132:135], v[80:95]
    ds_read_b128 v[136:139], v3 offset:6144
    ds_read_b128 v[140:143], v3 offset:10240
    s_waitcnt lgkmcnt(4)
    v_mfma_f32_32x32x16_bf16 v[80:95], v[160:163], a[136:139], v[80:95]
    s_nop 5
    v_pk_mul_f32 v[8:9], v[64:65], s[40:41]
    v_pk_mul_f32 v[10:11], v[66:67], s[40:41]
    v_exp_f32_e64 v8, v8 clamp
    v_exp_f32_e64 v9, v9 clamp
    v_exp_f32_e64 v10, v10 clamp
    v_exp_f32_e64 v11, v11 clamp
    v_mfma_f32_32x32x16_bf16 v[80:95], v[164:167], a[140:143], v[80:95]
    buffer_load_dwordx4 a[164:167], v3, s[16:19], s31 offen offset:1024 sc1
    ds_read_b128 v[144:147], v3 offset:14336
    ds_read_b128 v[148:151], v3 offset:18432
    v_max_f32 v12, 0, v64
    v_max_f32 v13, 0, v65
    v_max_f32 v14, 0, v66
    v_max_f32 v15, 0, v67
    v_pk_add_f32 v[8:9], v[8:9], s[38:39]
    v_pk_add_f32 v[10:11], v[10:11], s[38:39]
    v_mfma_f32_32x32x16_bf16 v[80:95], v[168:171], a[144:147], v[80:95]
    v_pk_add_f32 v[8:9], v[8:9], v[12:13]
    v_pk_add_f32 v[10:11], v[10:11], v[14:15]
    v_cvt_pk_bf16_f32 v176, v8, v9
    v_cvt_pk_bf16_f32 v177, v10, v11
    v_pk_mul_f32 v[8:9], v[68:69], s[40:41]
    v_pk_mul_f32 v[10:11], v[70:71], s[40:41]
    v_mfma_f32_32x32x16_bf16 v[80:95], v[172:175], a[148:151], v[80:95]
    ds_read_b128 v[152:155], v3 offset:22528
    ds_read_b128 v[156:159], v3 offset:26624
    v_exp_f32_e64 v8, v8 clamp
    buffer_load_dwordx4 a[168:171], v3, s[16:19], s31 offen offset:2048 sc1
    v_exp_f32_e64 v9, v9 clamp
    v_exp_f32_e64 v10, v10 clamp
    v_exp_f32_e64 v11, v11 clamp
    v_max_f32 v12, 0, v68
    v_max_f32 v13, 0, v69
    s_waitcnt lgkmcnt(4)
    v_mfma_f32_32x32x16_bf16 v[80:95], v[128:131], a[152:155], v[80:95]
    v_max_f32 v14, 0, v70
    v_max_f32 v15, 0, v71
    v_pk_add_f32 v[8:9], v[8:9], s[38:39]
    v_pk_add_f32 v[10:11], v[10:11], s[38:39]
    v_pk_add_f32 v[8:9], v[8:9], v[12:13]
    v_pk_add_f32 v[10:11], v[10:11], v[14:15]
    v_mfma_f32_32x32x16_bf16 v[80:95], v[132:135], a[156:159], v[80:95]
    ds_read_b128 v[160:163], v3 offset:30720
    ds_read_b128 v[164:167], v3 offset:7168
    v_cvt_pk_bf16_f32 v178, v8, v9
    v_cvt_pk_bf16_f32 v179, v10, v11
    buffer_load_dwordx4 a[172:175], v3, s[16:19], s31 offen offset:3072 sc1
    s_add_u32 s31, s31, 4096
    v_pk_mul_f32 v[8:9], v[72:73], s[40:41]
    v_pk_mul_f32 v[10:11], v[74:75], s[40:41]
    v_exp_f32_e64 v8, v8 clamp
    v_exp_f32_e64 v9, v9 clamp
    v_mfma_f32_32x32x16_bf16 v[96:111], v[136:139], a[132:135], v[96:111]
    v_exp_f32_e64 v10, v10 clamp
    v_exp_f32_e64 v11, v11 clamp
    v_max_f32 v12, 0, v72
    v_max_f32 v13, 0, v73
    v_max_f32 v14, 0, v74
    v_max_f32 v15, 0, v75
    v_mfma_f32_32x32x16_bf16 v[96:111], v[140:143], a[136:139], v[96:111]
    ds_read_b128 v[168:171], v3 offset:11264
    ds_read_b128 v[172:175], v3 offset:15360
    v_pk_add_f32 v[8:9], v[8:9], s[38:39]
    v_pk_add_f32 v[10:11], v[10:11], s[38:39]
    v_pk_add_f32 v[8:9], v[8:9], v[12:13]
    buffer_load_dwordx4 a[176:179], v3, s[16:19], s31 offen offset:0 sc1
    v_pk_add_f32 v[10:11], v[10:11], v[14:15]
    v_cvt_pk_bf16_f32 v180, v8, v9
    v_cvt_pk_bf16_f32 v181, v10, v11
    s_waitcnt lgkmcnt(4)
    v_mfma_f32_32x32x16_bf16 v[96:111], v[144:147], a[140:143], v[96:111]
    v_pk_mul_f32 v[8:9], v[76:77], s[40:41]
    v_pk_mul_f32 v[10:11], v[78:79], s[40:41]
    v_exp_f32_e64 v8, v8 clamp
    v_exp_f32_e64 v9, v9 clamp
    v_exp_f32_e64 v10, v10 clamp
    v_exp_f32_e64 v11, v11 clamp
    v_mfma_f32_32x32x16_bf16 v[96:111], v[148:151], a[144:147], v[96:111]
    ds_read_b128 v[128:131], v3 offset:19456
    ds_read_b128 v[132:135], v3 offset:23552
    v_max_f32 v12, 0, v76
    v_max_f32 v13, 0, v77
    v_max_f32 v14, 0, v78
    v_max_f32 v15, 0, v79
    buffer_load_dwordx4 a[180:183], v3, s[16:19], s31 offen offset:1024 sc1
    v_pk_add_f32 v[8:9], v[8:9], s[38:39]
    v_pk_add_f32 v[10:11], v[10:11], s[38:39]
    v_mfma_f32_32x32x16_bf16 v[96:111], v[152:155], a[148:151], v[96:111]
    v_pk_add_f32 v[8:9], v[8:9], v[12:13]
    v_pk_add_f32 v[10:11], v[10:11], v[14:15]
    v_cvt_pk_bf16_f32 v182, v8, v9
    v_cvt_pk_bf16_f32 v183, v10, v11
    buffer_store_dwordx4 v[176:179], v3, s[16:19], s33 offen offset:0 sc1
    buffer_store_dwordx4 v[180:183], v3, s[16:19], s33 offen offset:1024 sc1
    v_pk_mul_f32 v[8:9], v[80:81], s[40:41]
    v_mfma_f32_32x32x16_bf16 v[96:111], v[156:159], a[152:155], v[96:111]
    ds_read_b128 v[136:139], v3 offset:27648
    ds_read_b128 v[140:143], v3 offset:31744
    v_pk_mul_f32 v[10:11], v[82:83], s[40:41]
    v_exp_f32_e64 v8, v8 clamp
    v_exp_f32_e64 v9, v9 clamp
    v_exp_f32_e64 v10, v10 clamp
    v_exp_f32_e64 v11, v11 clamp
    v_max_f32 v12, 0, v80
    s_waitcnt lgkmcnt(4)
    v_mfma_f32_32x32x16_bf16 v[96:111], v[160:163], a[156:159], v[96:111]
    v_max_f32 v13, 0, v81
    v_max_f32 v14, 0, v82
    v_max_f32 v15, 0, v83
    v_pk_add_f32 v[8:9], v[8:9], s[38:39]
    v_pk_add_f32 v[10:11], v[10:11], s[38:39]
    v_pk_add_f32 v[8:9], v[8:9], v[12:13]
    buffer_load_dwordx4 a[184:187], v3, s[16:19], s31 offen offset:2048 sc1
    v_mfma_f32_32x32x16_bf16 v[112:127], v[164:167], a[132:135], v[112:127]
    v_pk_add_f32 v[10:11], v[10:11], v[14:15]
    v_cvt_pk_bf16_f32 v184, v8, v9
    v_cvt_pk_bf16_f32 v185, v10, v11
    v_pk_mul_f32 v[8:9], v[84:85], s[40:41]
    v_pk_mul_f32 v[10:11], v[86:87], s[40:41]
    v_exp_f32_e64 v8, v8 clamp
    v_mfma_f32_32x32x16_bf16 v[112:127], v[168:171], a[136:139], v[112:127]
    v_exp_f32_e64 v9, v9 clamp
    v_exp_f32_e64 v10, v10 clamp
    v_exp_f32_e64 v11, v11 clamp
    v_max_f32 v12, 0, v84
    v_max_f32 v13, 0, v85
    v_max_f32 v14, 0, v86
    v_mfma_f32_32x32x16_bf16 v[112:127], v[172:175], a[140:143], v[112:127]
    buffer_load_dwordx4 a[188:191], v3, s[16:19], s31 offen offset:3072 sc1
    s_add_u32 s31, s31, 4096
    v_max_f32 v15, 0, v87
    v_pk_add_f32 v[8:9], v[8:9], s[38:39]
    v_pk_add_f32 v[10:11], v[10:11], s[38:39]
    v_pk_add_f32 v[8:9], v[8:9], v[12:13]
    v_pk_add_f32 v[10:11], v[10:11], v[14:15]
    v_cvt_pk_bf16_f32 v186, v8, v9
    s_waitcnt lgkmcnt(0)
    v_mfma_f32_32x32x16_bf16 v[112:127], v[128:131], a[144:147], v[112:127]
    v_cvt_pk_bf16_f32 v187, v10, v11
    v_pk_mul_f32 v[8:9], v[88:89], s[40:41]
    v_pk_mul_f32 v[10:11], v[90:91], s[40:41]
    v_exp_f32_e64 v8, v8 clamp
    v_exp_f32_e64 v9, v9 clamp
    v_exp_f32_e64 v10, v10 clamp
    v_mfma_f32_32x32x16_bf16 v[112:127], v[132:135], a[148:151], v[112:127]
    v_exp_f32_e64 v11, v11 clamp
    v_max_f32 v12, 0, v88
    buffer_load_dwordx4 a[192:195], v3, s[16:19], s31 offen offset:0 sc1
    v_max_f32 v13, 0, v89
    v_max_f32 v14, 0, v90
    v_max_f32 v15, 0, v91
    v_pk_add_f32 v[8:9], v[8:9], s[38:39]
    v_mfma_f32_32x32x16_bf16 v[112:127], v[136:139], a[152:155], v[112:127]
    v_pk_add_f32 v[10:11], v[10:11], s[38:39]
    v_pk_add_f32 v[8:9], v[8:9], v[12:13]
    v_pk_add_f32 v[10:11], v[10:11], v[14:15]
    v_cvt_pk_bf16_f32 v188, v8, v9
    v_cvt_pk_bf16_f32 v189, v10, v11
    v_pk_mul_f32 v[8:9], v[92:93], s[40:41]
    v_mfma_f32_32x32x16_bf16 v[112:127], v[140:143], a[156:159], v[112:127]
    v_pk_mul_f32 v[10:11], v[94:95], s[40:41]
    v_exp_f32_e64 v8, v8 clamp
    v_exp_f32_e64 v9, v9 clamp
    v_exp_f32_e64 v10, v10 clamp
    v_exp_f32_e64 v11, v11 clamp
    buffer_load_dwordx4 a[196:199], v3, s[16:19], s31 offen offset:1024 sc1
    v_max_f32 v12, 0, v92
    v_max_f32 v13, 0, v93
    v_max_f32 v14, 0, v94
    v_max_f32 v15, 0, v95
    v_pk_add_f32 v[8:9], v[8:9], s[38:39]
    v_pk_add_f32 v[10:11], v[10:11], s[38:39]
    v_pk_add_f32 v[8:9], v[8:9], v[12:13]
    v_pk_add_f32 v[10:11], v[10:11], v[14:15]
    v_cvt_pk_bf16_f32 v190, v8, v9
    v_cvt_pk_bf16_f32 v191, v10, v11
    buffer_store_dwordx4 v[184:187], v3, s[16:19], s33 offen offset:2048 sc1
    buffer_store_dwordx4 v[188:191], v3, s[16:19], s33 offen offset:3072 sc1
    s_add_u32 s33, s33, 4096
    v_pk_mul_f32 v[8:9], v[96:97], s[40:41]
    v_pk_mul_f32 v[10:11], v[98:99], s[40:41]
    v_exp_f32_e64 v8, v8 clamp
    v_exp_f32_e64 v9, v9 clamp
    v_exp_f32_e64 v10, v10 clamp
    v_exp_f32_e64 v11, v11 clamp
    v_max_f32 v12, 0, v96
    v_max_f32 v13, 0, v97
    v_max_f32 v14, 0, v98
    v_max_f32 v15, 0, v99
    v_pk_add_f32 v[8:9], v[8:9], s[38:39]
    v_pk_add_f32 v[10:11], v[10:11], s[38:39]
    v_pk_add_f32 v[8:9], v[8:9], v[12:13]
    v_pk_add_f32 v[10:11], v[10:11], v[14:15]
    v_cvt_pk_bf16_f32 v192, v8, v9
    v_cvt_pk_bf16_f32 v193, v10, v11
    v_pk_mul_f32 v[8:9], v[100:101], s[40:41]
    buffer_load_dwordx4 a[200:203], v3, s[16:19], s31 offen offset:2048 sc1
    v_pk_mul_f32 v[10:11], v[102:103], s[40:41]
    v_exp_f32_e64 v8, v8 clamp
    v_exp_f32_e64 v9, v9 clamp
    v_exp_f32_e64 v10, v10 clamp
    v_exp_f32_e64 v11, v11 clamp
    v_max_f32 v12, 0, v100
    v_max_f32 v13, 0, v101
    v_max_f32 v14, 0, v102
    v_max_f32 v15, 0, v103
    v_pk_add_f32 v[8:9], v[8:9], s[38:39]
    v_pk_add_f32 v[10:11], v[10:11], s[38:39]
    v_pk_add_f32 v[8:9], v[8:9], v[12:13]
    v_pk_add_f32 v[10:11], v[10:11], v[14:15]
    v_cvt_pk_bf16_f32 v194, v8, v9
    v_cvt_pk_bf16_f32 v195, v10, v11
    v_pk_mul_f32 v[8:9], v[104:105], s[40:41]
    v_pk_mul_f32 v[10:11], v[106:107], s[40:41]
    buffer_load_dwordx4 a[204:207], v3, s[16:19], s31 offen offset:3072 sc1
    s_add_u32 s31, s31, 4096
    v_exp_f32_e64 v8, v8 clamp
    v_exp_f32_e64 v9, v9 clamp
    v_exp_f32_e64 v10, v10 clamp
    v_exp_f32_e64 v11, v11 clamp
    v_max_f32 v12, 0, v104
    v_max_f32 v13, 0, v105
    v_max_f32 v14, 0, v106
    v_max_f32 v15, 0, v107
    v_pk_add_f32 v[8:9], v[8:9], s[38:39]
    v_pk_add_f32 v[10:11], v[10:11], s[38:39]
    v_pk_add_f32 v[8:9], v[8:9], v[12:13]
    v_pk_add_f32 v[10:11], v[10:11], v[14:15]
    v_cvt_pk_bf16_f32 v196, v8, v9
    v_cvt_pk_bf16_f32 v197, v10, v11
    v_pk_mul_f32 v[8:9], v[108:109], s[40:41]
    v_pk_mul_f32 v[10:11], v[110:111], s[40:41]
    v_exp_f32_e64 v8, v8 clamp
    buffer_load_dwordx4 a[208:211], v3, s[16:19], s31 offen offset:0 sc1
    v_exp_f32_e64 v9, v9 clamp
    v_exp_f32_e64 v10, v10 clamp
    v_exp_f32_e64 v11, v11 clamp
    v_max_f32 v12, 0, v108
    v_max_f32 v13, 0, v109
    v_max_f32 v14, 0, v110
    v_max_f32 v15, 0, v111
    v_pk_add_f32 v[8:9], v[8:9], s[38:39]
    v_pk_add_f32 v[10:11], v[10:11], s[38:39]
    v_pk_add_f32 v[8:9], v[8:9], v[12:13]
    v_pk_add_f32 v[10:11], v[10:11], v[14:15]
    v_cvt_pk_bf16_f32 v198, v8, v9
    v_cvt_pk_bf16_f32 v199, v10, v11
    buffer_store_dwordx4 v[192:195], v3, s[16:19], s33 offen offset:0 sc1
    buffer_store_dwordx4 v[196:199], v3, s[16:19], s33 offen offset:1024 sc1
    v_pk_mul_f32 v[8:9], v[112:113], s[40:41]
    v_pk_mul_f32 v[10:11], v[114:115], s[40:41]
    v_exp_f32_e64 v8, v8 clamp
    v_exp_f32_e64 v9, v9 clamp
    v_exp_f32_e64 v10, v10 clamp
    v_exp_f32_e64 v11, v11 clamp
    v_max_f32 v12, 0, v112
    v_max_f32 v13, 0, v113
    v_max_f32 v14, 0, v114
    v_max_f32 v15, 0, v115
    v_pk_add_f32 v[8:9], v[8:9], s[38:39]
    v_pk_add_f32 v[10:11], v[10:11], s[38:39]
    v_pk_add_f32 v[8:9], v[8:9], v[12:13]
    v_pk_add_f32 v[10:11], v[10:11], v[14:15]
    v_cvt_pk_bf16_f32 v200, v8, v9
    v_cvt_pk_bf16_f32 v201, v10, v11
    v_pk_mul_f32 v[8:9], v[116:117], s[40:41]
    buffer_load_dwordx4 a[212:215], v3, s[16:19], s31 offen offset:1024 sc1
    v_pk_mul_f32 v[10:11], v[118:119], s[40:41]
    v_exp_f32_e64 v8, v8 clamp
    v_exp_f32_e64 v9, v9 clamp
    v_exp_f32_e64 v10, v10 clamp
    v_exp_f32_e64 v11, v11 clamp
    v_max_f32 v12, 0, v116
    v_max_f32 v13, 0, v117
    v_max_f32 v14, 0, v118
    v_max_f32 v15, 0, v119
    v_pk_add_f32 v[8:9], v[8:9], s[38:39]
    v_pk_add_f32 v[10:11], v[10:11], s[38:39]
    v_pk_add_f32 v[8:9], v[8:9], v[12:13]
    v_pk_add_f32 v[10:11], v[10:11], v[14:15]
    v_cvt_pk_bf16_f32 v202, v8, v9
    v_cvt_pk_bf16_f32 v203, v10, v11
    v_pk_mul_f32 v[8:9], v[120:121], s[40:41]
    v_pk_mul_f32 v[10:11], v[122:123], s[40:41]
    buffer_load_dwordx4 a[216:219], v3, s[16:19], s31 offen offset:2048 sc1
    v_exp_f32_e64 v8, v8 clamp
    v_exp_f32_e64 v9, v9 clamp
    v_exp_f32_e64 v10, v10 clamp
    v_exp_f32_e64 v11, v11 clamp
    v_max_f32 v12, 0, v120
    v_max_f32 v13, 0, v121
    v_max_f32 v14, 0, v122
    v_max_f32 v15, 0, v123
    v_pk_add_f32 v[8:9], v[8:9], s[38:39]
    v_pk_add_f32 v[10:11], v[10:11], s[38:39]
    v_pk_add_f32 v[8:9], v[8:9], v[12:13]
    v_pk_add_f32 v[10:11], v[10:11], v[14:15]
    v_cvt_pk_bf16_f32 v204, v8, v9
    v_cvt_pk_bf16_f32 v205, v10, v11
    v_pk_mul_f32 v[8:9], v[124:125], s[40:41]
    v_pk_mul_f32 v[10:11], v[126:127], s[40:41]
    v_exp_f32_e64 v8, v8 clamp
    buffer_load_dwordx4 a[220:223], v3, s[16:19], s31 offen offset:3072 sc1
    s_add_u32 s31, s31, 4096
    v_exp_f32_e64 v9, v9 clamp
    v_exp_f32_e64 v10, v10 clamp
    v_exp_f32_e64 v11, v11 clamp
    v_max_f32 v12, 0, v124
    v_max_f32 v13, 0, v125
    v_max_f32 v14, 0, v126
    v_max_f32 v15, 0, v127
    v_pk_add_f32 v[8:9], v[8:9], s[38:39]
    v_pk_add_f32 v[10:11], v[10:11], s[38:39]
    v_pk_add_f32 v[8:9], v[8:9], v[12:13]
    v_pk_add_f32 v[10:11], v[10:11], v[14:15]
    v_cvt_pk_bf16_f32 v206, v8, v9
    v_cvt_pk_bf16_f32 v207, v10, v11
    buffer_store_dwordx4 v[200:203], v3, s[16:19], s33 offen offset:2048 sc1
    buffer_store_dwordx4 v[204:207], v3, s[16:19], s33 offen offset:3072 sc1
    buffer_load_dwordx4 a[224:227], v3, s[16:19], s31 offen offset:0 sc1
    buffer_load_dwordx4 a[228:231], v3, s[16:19], s31 offen offset:1024 sc1
    buffer_load_dwordx4 a[232:235], v3, s[16:19], s31 offen offset:2048 sc1
    buffer_load_dwordx4 a[236:239], v3, s[16:19], s31 offen offset:3072 sc1
    s_add_u32 s31, s31, 4096
    buffer_load_dwordx4 a[240:243], v3, s[16:19], s31 offen offset:0 sc1
    buffer_load_dwordx4 a[44:47], v3, s[16:19], s31 offen offset:1024 sc1
    buffer_load_dwordx4 a[48:51], v3, s[16:19], s31 offen offset:2048 sc1
    buffer_load_dwordx4 a[52:55], v3, s[16:19], s31 offen offset:3072 sc1
    s_add_u32 s31, s31, 4096
    buffer_load_dwordx4 a[56:59], v3, s[16:19], s31 offen offset:0 sc1
    buffer_load_dwordx4 a[60:63], v3, s[16:19], s31 offen offset:1024 sc1
    buffer_load_dwordx4 a[64:67], v3, s[16:19], s31 offen offset:2048 sc1
    buffer_load_dwordx4 a[68:71], v3, s[16:19], s31 offen offset:3072 sc1
    s_add_u32 s31, s31, 4096
    buffer_load_dwordx4 a[72:75], v3, s[16:19], s31 offen offset:0 sc1
    buffer_load_dwordx4 a[76:79], v3, s[16:19], s31 offen offset:1024 sc1
    buffer_load_dwordx4 a[80:83], v3, s[16:19], s31 offen offset:2048 sc1
    buffer_load_dwordx4 a[84:87], v3, s[16:19], s31 offen offset:3072 sc1
    s_add_u32 s31, s31, 4096
    buffer_load_dwordx4 a[88:91], v3, s[16:19], s31 offen offset:0 sc1
    buffer_load_dwordx4 a[92:95], v3, s[16:19], s31 offen offset:1024 sc1
    buffer_load_dwordx4 a[96:99], v3, s[16:19], s31 offen offset:2048 sc1
    buffer_load_dwordx4 a[100:103], v3, s[16:19], s31 offen offset:3072 sc1
    s_add_u32 s31, s31, 4096
    s_waitcnt vmcnt(20)
p1_fin:
    s_barrier
    s_cmp_lg_u32 s20, 1
    s_cbranch_scc1 sig4
    v_lshlrev_b32 v7, 12, v1
    s_lshr_b32 s42, s45, 3
    s_lshl_b32 s42, s42, 7
    s_and_b32 s43, s45, 7
    s_lshl_b32 s43, s43, 2
    s_add_u32 s42, s42, s43
    s_add_u32 s42, s42, 655360
    v_mov_b32 v6, s44
    s_mov_b64 exec, 255
    buffer_store_dword v6, v7, s[16:19], s42 offen sc1
    s_mov_b64 exec, -1
sig4:
    s_cmp_lg_u32 s45, 0
    s_cbranch_scc1 p1_noep
    s_cmp_lg_u32 s20, 1
    s_cbranch_scc1 sig5
    v_mov_b32 v7, 0
    s_mov_b32 s42, 0
    v_mov_b32 v6, s44
    s_mov_b64 exec, 1
    buffer_store_dword v6, v7, s[16:19], s42 offen sc1
    s_mov_b64 exec, -1
sig5:
p1_noep:
    v_mov_b32 v5, v24
    v_mov_b32 v2, v26
    s_mov_b32 s26, s50
    s_mov_b32 s27, s51
    global_load_ushort v252, v27, s[58:59]
    s_add_u32 m0, s55, 90112
    s_nop 0
    global_load_lds_dwordx4 v229, s[48:49] nt
    s_add_u32 m0, s55, 91136
    s_nop 0
    global_load_lds_dwordx4 v230, s[48:49] nt
    s_add_u32 m0, s55, 92160
    s_nop 0
    global_load_lds_dwordx4 v231, s[48:49] nt
    v_and_b32 v5, 31, v1
    v_mul_u32_u24 v5, 320, v5
    v_lshrrev_b32 v8, 5, v1
    v_lshl_add_u32 v5, v8, 3, v5
    s_lshl_b32 s33, s20, 4
    s_add_u32 s33, s33, 90112
    v_add_u32 v5, s33, v5
    buffer_load_dwordx4 a[104:107], v3, s[16:19], s31 offen offset:0 sc1
    buffer_load_dwordx4 a[108:111], v3, s[16:19], s31 offen offset:1024 sc1
    buffer_load_dwordx4 a[112:115], v3, s[16:19], s31 offen offset:2048 sc1
    buffer_load_dwordx4 a[116:119], v3, s[16:19], s31 offen offset:3072 sc1
    s_add_u32 s31, s31, 4096
    buffer_load_dwordx4 a[120:123], v3, s[16:19], s31 offen offset:0 sc1
    buffer_load_dwordx4 a[124:127], v3, s[16:19], s31 offen offset:1024 sc1
    buffer_load_dwordx4 a[128:131], v3, s[16:19], s31 offen offset:2048 sc1
    buffer_load_dwordx4 a[132:135], v3, s[16:19], s31 offen offset:3072 sc1
    s_add_u32 s31, s31, 4096
    s_mul_i32 s25, s27, 122880
    s_add_u32 s25, s25, 7340032
    s_cmp_eq_u32 s20, 0
    s_cbranch_scc1 p1_now1
    s_sub_u32 s23, s20, 1
    s_mul_i32 s23, s23, 0
    s_add_u32 s24, s25, s23
    s_waitcnt vmcnt(0)
p1_now1:
    s_mul_i32 s21, s20, 13440
    s_add_u32 s21, s21, 131072
    s_mul_i32 s23, s20, 15360
    s_add_u32 s23, s23, 102464
    s_mul_i32 s22, s29, 40960
    s_mul_i32 s33, s20, 10240
    s_add_u32 s22, s22, s33
    s_add_u32 s22, s22, 11534336
    v_bfe_u32 v8, v1, 2, 3
    v_lshlrev_b32 v8, 2, v8
    v_and_b32 v9, 3, v1
    s_mov_b32 s33, 0x55524130
    s_mov_b32 s34, 0x55453120
    v_bfe_u32 v10, s33, v8, 4
    v_bfe_u32 v11, s34, v8, 4
    v_lshl_add_u32 v10, v10, 2, v9
    v_lshl_add_u32 v11, v11, 2, v9
    v_min_u32 v10, 20, v10
    v_min_u32 v11, 20, v11
    v_lshrrev_b32 v12, 5, v1
    v_lshlrev_b32 v12, 4, v12
    s_sub_u32 s33, s23, 16
    v_add_u32 v12, s33, v12
    v_mul_u32_u24 v10, 80, v10
    v_mul_u32_u24 v11, 80, v11
    v_add_u32 v10, v10, v12
    v_add_u32 v11, v11, v12
    s_lshl_b32 s28, s26, 2
    s_add_u32 s28, s28, s20
    s_mov_b32 s36, 0
    s_mov_b32 s37, -1
    s_lshl_b32 s35, s13, 2
    s_add_u32 s35, s35, s20
    s_mul_i32 s35, s35, 61440
    s_add_u32 s35, s35, 9437184
    s_mul_i32 s6, s29, 40
    s_mul_i32 s33, s30, 10
    s_add_u32 s6, s6, s33
    s_lshr_b32 s33, s20, 1
    s_add_u32 s6, s6, s33
    s_lshl_b32 s6, s6, 10
    s_and_b32 s33, s20, 1
    s_lshl_b32 s33, s33, 9
    s_add_u32 s6, s6, s33
    s_add_u32 s6, s6, 14680064
    v_and_b32 v8, 31, v1
    v_lshrrev_b32 v9, 5, v1
    v_lshlrev_b32 v12, 3, v8
    v_lshlrev_b32 v8, 4, v8
    v_lshl_add_u32 v253, v9, 11, v8
    v_lshl_add_u32 v8, v9, 3, v8
    v_mov_b32 v9, v253
    s_lshl_b32 s7, s29, 4
    s_lshl_b32 s33, s30, 2
    s_add_u32 s7, s7, s33
    s_add_u32 s7, s7, s20
    s_lshl_b32 s7, s7, 8
    s_add_u32 s7, s7, 262144
    s_and_b32 s42, s2, 7
    s_lshl_b32 s42, s42, 12
    s_add_u32 s42, s42, 655360
    v_lshrrev_b32 v18, 1, v1
    v_lshlrev_b32 v18, 7, v18
    v_and_b32 v14, 1, v1
    v_lshl_add_u32 v18, v14, 4, v18
    s_cmp_lg_u32 s20, 0
    s_cbranch_scc1 poll4d
    s_mov_b32 s43, 0x20000
poll4:
    buffer_load_dwordx4 v[14:17], v18, s[16:19], s42 offen sc1
    s_waitcnt vmcnt(0)
    v_xor_b32 v14, s44, v14
    v_xor_b32 v15, s44, v15
    v_xor_b32 v16, s44, v16
    v_xor_b32 v17, s44, v17
    v_or3_b32 v14, v14, v15, v16
    v_or_b32 v14, v14, v17
    v_cmp_ne_u32 vcc, 0, v14
    s_cbranch_vccz poll4d
    s_sleep 8
    s_sub_u32 s43, s43, 1
    s_cbranch_scc0 poll4
poll4d:
    s_barrier
    s_add_u32 m0, s23, 0
    s_nop 0
    buffer_load_dwordx4 v3, s[16:19], s21 offen offset:0 sc1 lds
    buffer_load_dwordx4 v3, s[16:19], s21 offen offset:1024 sc1 lds
    buffer_load_dwordx4 v3, s[16:19], s21 offen offset:2048 sc1 lds
    buffer_load_dwordx4 v3, s[16:19], s21 offen offset:3072 sc1 lds
    s_add_u32 s21, s21, 4096
    s_add_u32 m0, s23, 4096
    s_nop 0
    buffer_load_dwordx4 v3, s[16:19], s21 offen offset:0 sc1 lds
    buffer_load_dwordx4 v3, s[16:19], s21 offen offset:1024 sc1 lds
    buffer_load_dwordx4 v3, s[16:19], s21 offen offset:2048 sc1 lds
    buffer_load_dwordx4 a[0:3], v3, s[16:19], s22 offen offset:0 sc1
    buffer_load_dwordx4 a[4:7], v3, s[16:19], s22 offen offset:1024 sc1
    buffer_load_dwordx4 v3, s[16:19], s21 offen offset:3072 sc1 lds
    s_add_u32 s21, s21, 4096
    s_add_u32 m0, s23, 8192
    s_nop 0
    buffer_load_dwordx4 v3, s[16:19], s21 offen offset:0 sc1 lds
    buffer_load_dwordx4 v3, s[16:19], s21 offen offset:1024 sc1 lds
    buffer_load_dwordx4 v3, s[16:19], s21 offen offset:2048 sc1 lds
    buffer_load_dwordx4 v3, s[16:19], s21 offen offset:3072 sc1 lds
    s_add_u32 s21, s21, 4096
    s_add_u32 m0, s23, 12288
    s_nop 0
    buffer_load_dwordx4 v3, s[16:19], s21 offen offset:0 sc1 lds
    buffer_load_dwordx4 v3, s[16:19], s21 offen offset:1024 sc1 lds
    buffer_load_dwordx4 a[8:11], v3, s[16:19], s22 offen offset:2048 sc1
    buffer_load_dwordx4 a[12:15], v3, s[16:19], s22 offen offset:3072 sc1
    s_add_u32 s22, s22, 4096
    s_mul_i32 s24, s20, 22528
    s_add_u32 s24, s24, 0
    s_add_u32 s25, s25, s24
    v_mov_b32 v26, 0
    v_mov_b32 v27, 0
    v_mov_b32 v34, 0
    v_mov_b32 v35, 0
    v_mov_b32 v36, 0
    v_mov_b32 v37, 0
    v_mov_b32 v44, 0
    v_mov_b32 v45, 0
    v_mov_b32 v58, 0
    v_mov_b32 v59, 0
    v_mov_b32 v66, 0
    v_mov_b32 v67, 0
    v_mov_b32 v68, 0
    v_mov_b32 v69, 0
    v_mov_b32 v76, 0
    v_mov_b32 v77, 0
    s_waitcnt vmcnt(11)
    ds_read_b128 v[84:87], v10 offset:16
    buffer_load_dwordx4 a[16:19], v3, s[16:19], s22 offen offset:0 sc1
    ds_read_b128 v[88:91], v10 offset:48
    ds_read_b128 v[92:95], v10 offset:80
    ds_read_b128 v[96:99], v11 offset:1680
    ds_read_b128 v[100:103], v11 offset:1712
    ds_read_b128 v[104:107], v11 offset:1744
    ds_read_b128 v[108:111], v10 offset:3376
    ds_read_b128 v[112:115], v10 offset:3408
    ds_read_b128 v[116:119], v10 offset:3440
    ds_read_b128 v[120:123], v11 offset:5040
    buffer_load_dwordx4 a[20:23], v3, s[16:19], s22 offen offset:1024 sc1
    ds_read_b128 v[124:127], v11 offset:5072
    ds_read_b128 v[128:131], v11 offset:5104
    s_waitcnt lgkmcnt(11)
    v_cvt_pk_bf16_f32 v20, v84, v85
    v_cvt_pk_bf16_f32 v21, v86, v87
    s_waitcnt lgkmcnt(10)
    v_cvt_pk_bf16_f32 v22, v88, v89
    v_cvt_pk_bf16_f32 v23, v90, v91
    s_waitcnt lgkmcnt(9)
    v_cvt_pk_bf16_f32 v24, v92, v93
    v_cvt_pk_bf16_f32 v25, v94, v95
    buffer_load_dwordx4 a[24:27], v3, s[16:19], s22 offen offset:2048 sc1
    v_cndmask_b32 v24, v24, 0, s[36:37]
    v_cndmask_b32 v25, v25, 0, s[36:37]
    s_waitcnt vmcnt(13)
    v_mfma_f32_32x32x16_bf16 v[180:195], v[20:23], a[0:3], 0
    s_waitcnt vmcnt(12)
    v_mfma_f32_32x32x16_bf16 v[180:195], v[24:27], a[4:7], v[180:195]
    buffer_load_dwordx4 a[28:31], v3, s[16:19], s22 offen offset:3072 sc1
    s_add_u32 s22, s22, 4096
    s_waitcnt lgkmcnt(8)
    v_cvt_pk_bf16_f32 v28, v96, v97
    v_cvt_pk_bf16_f32 v29, v98, v99
    v_cndmask_b32 v28, 0, v28, s[36:37]
    v_cndmask_b32 v29, 0, v29, s[36:37]
    s_waitcnt lgkmcnt(7)
    v_cvt_pk_bf16_f32 v30, v100, v101
    v_cvt_pk_bf16_f32 v31, v102, v103
    s_waitcnt lgkmcnt(6)
    v_cvt_pk_bf16_f32 v32, v104, v105
    v_cvt_pk_bf16_f32 v33, v106, v107
    buffer_load_dwordx4 a[32:35], v3, s[16:19], s22 offen offset:0 sc1
    v_mfma_f32_32x32x16_bf16 v[196:211], v[28:31], a[4:7], 0
    s_waitcnt vmcnt(6)
    v_mfma_f32_32x32x16_bf16 v[196:211], v[32:35], a[8:11], v[196:211]
    buffer_load_dwordx4 a[36:39], v3, s[16:19], s22 offen offset:1024 sc1
    ds_read_b128 v[132:135], v10 offset:6736
    ds_read_b128 v[136:139], v10 offset:6768
    ds_read_b128 v[140:143], v10 offset:6800
    ds_read_b128 v[144:147], v11 offset:8400
    ds_read_b128 v[148:151], v11 offset:8432
    ds_read_b128 v[152:155], v11 offset:8464
    ds_read_b128 v[156:159], v10 offset:10096
    ds_read_b128 v[160:163], v10 offset:10128
    ds_read_b128 v[164:167], v10 offset:10160
    buffer_load_dwordx4 a[136:139], v3, s[16:19], s31 offen offset:0 sc1
    ds_read_b128 v[168:171], v11 offset:11760
    ds_read_b128 v[172:175], v11 offset:11792
    ds_read_b128 v[176:179], v11 offset:11824
    s_waitcnt lgkmcnt(15)
    v_cvt_pk_bf16_f32 v38, v108, v109
    v_cvt_pk_bf16_f32 v39, v110, v111
    s_waitcnt lgkmcnt(15)
    v_cvt_pk_bf16_f32 v40, v112, v113
    v_cvt_pk_bf16_f32 v41, v114, v115
    s_waitcnt lgkmcnt(15)
    v_cvt_pk_bf16_f32 v42, v116, v117
    v_cvt_pk_bf16_f32 v43, v118, v119
    buffer_load_dwordx4 a[140:143], v3, s[16:19], s31 offen offset:1024 sc1
    v_cndmask_b32 v42, v42, 0, s[36:37]
    v_cndmask_b32 v43, v43, 0, s[36:37]
    v_mfma_f32_32x32x16_bf16 v[212:227], v[36:39], a[8:11], 0
    s_waitcnt vmcnt(8)
    v_mfma_f32_32x32x16_bf16 v[212:227], v[40:43], a[12:15], v[212:227]
    buffer_load_dwordx4 a[144:147], v3, s[16:19], s31 offen offset:2048 sc1
    s_waitcnt lgkmcnt(14)
    v_cvt_pk_bf16_f32 v46, v120, v121
    v_cvt_pk_bf16_f32 v47, v122, v123
    v_cndmask_b32 v46, 0, v46, s[36:37]
    v_cndmask_b32 v47, 0, v47, s[36:37]
    s_waitcnt lgkmcnt(13)
    v_cvt_pk_bf16_f32 v48, v124, v125
    v_cvt_pk_bf16_f32 v49, v126, v127
    s_waitcnt lgkmcnt(12)
    v_cvt_pk_bf16_f32 v50, v128, v129
    v_cvt_pk_bf16_f32 v51, v130, v131
    buffer_load_dwordx4 a[148:151], v3, s[16:19], s31 offen offset:3072 sc1
    s_add_u32 s31, s31, 4096
    v_mfma_f32_32x32x16_bf16 v[228:243], v[44:47], a[12:15], 0
    s_waitcnt vmcnt(9)
    v_mfma_f32_32x32x16_bf16 v[228:243], v[48:51], a[16:19], v[228:243]
    buffer_load_dwordx4 a[152:155], v3, s[16:19], s31 offen offset:0 sc1
    s_waitcnt lgkmcnt(11)
    v_cvt_pk_bf16_f32 v52, v132, v133
    v_cvt_pk_bf16_f32 v53, v134, v135
    s_waitcnt lgkmcnt(10)
    v_cvt_pk_bf16_f32 v54, v136, v137
    v_cvt_pk_bf16_f32 v55, v138, v139
    s_waitcnt lgkmcnt(9)
    v_cvt_pk_bf16_f32 v56, v140, v141
    v_cvt_pk_bf16_f32 v57, v142, v143
    v_cndmask_b32 v56, v56, 0, s[36:37]
    v_cndmask_b32 v57, v57, 0, s[36:37]
    buffer_load_dwordx4 a[156:159], v3, s[16:19], s31 offen offset:1024 sc1
    s_waitcnt lgkmcnt(8)
    v_cvt_pk_bf16_f32 v60, v144, v145
    v_cvt_pk_bf16_f32 v61, v146, v147
    v_cndmask_b32 v60, 0, v60, s[36:37]
    v_cndmask_b32 v61, 0, v61, s[36:37]
    s_waitcnt lgkmcnt(7)
    v_cvt_pk_bf16_f32 v62, v148, v149
    v_cvt_pk_bf16_f32 v63, v150, v151
    s_waitcnt lgkmcnt(6)
    v_cvt_pk_bf16_f32 v64, v152, v153
    v_cvt_pk_bf16_f32 v65, v154, v155
    buffer_load_dword v244, v2, s[16:19], s54 offen sc1
    s_add_u32 s54, s54, 6144
    buffer_load_dword v245, v2, s[16:19], s54 offen sc1
    s_add_u32 s54, s54, 6144
    buffer_load_dword v246, v2, s[16:19], s54 offen sc1
    s_add_u32 s54, s54, 6144
    buffer_load_dword v247, v2, s[16:19], s54 offen sc1
    s_add_u32 s54, s54, 6144
    s_waitcnt lgkmcnt(5)
    v_cvt_pk_bf16_f32 v70, v156, v157
    v_cvt_pk_bf16_f32 v71, v158, v159
    s_waitcnt lgkmcnt(4)
    v_cvt_pk_bf16_f32 v72, v160, v161
    v_cvt_pk_bf16_f32 v73, v162, v163
    s_waitcnt lgkmcnt(3)
    v_cvt_pk_bf16_f32 v74, v164, v165
    v_cvt_pk_bf16_f32 v75, v166, v167
    v_cndmask_b32 v74, v74, 0, s[36:37]
    v_cndmask_b32 v75, v75, 0, s[36:37]
    buffer_load_dword v248, v2, s[16:19], s54 offen sc1
    s_add_u32 s54, s54, 6144
    buffer_load_dword v249, v2, s[16:19], s54 offen sc1
    s_add_u32 s54, s54, 6144
    buffer_load_dword v250, v2, s[16:19], s54 offen sc1
    s_add_u32 s54, s54, 6144
    buffer_load_dword v251, v2, s[16:19], s54 offen sc1
    s_add_u32 s54, s54, 6144
    s_waitcnt lgkmcnt(2)
    v_cvt_pk_bf16_f32 v78, v168, v169
    v_cvt_pk_bf16_f32 v79, v170, v171
    v_cndmask_b32 v78, 0, v78, s[36:37]
    v_cndmask_b32 v79, 0, v79, s[36:37]
    s_waitcnt lgkmcnt(1)
    v_cvt_pk_bf16_f32 v80, v172, v173
    v_cvt_pk_bf16_f32 v81, v174, v175
    s_waitcnt lgkmcnt(0)
    v_cvt_pk_bf16_f32 v82, v176, v177
    v_cvt_pk_bf16_f32 v83, v178, v179
    s_add_u32 m0, s24, 0
    s_nop 0
    buffer_load_dwordx4 v3, s[16:19], s25 offen offset:0 sc1 lds
    v_cndmask_b32 v16, v192, v188, s[36:37]
    v_add_f32 v16, s38, v16
    v_rcp_f32 v16, v16
    s_nop 0
    v_pk_mul_f32 v[180:181], v[180:181], v[16:17] op_sel_hi:[1,0]
    v_pk_mul_f32 v[182:183], v[182:183], v[16:17] op_sel_hi:[1,0]
    v_pk_mul_f32 v[184:185], v[184:185], v[16:17] op_sel_hi:[1,0]
    v_pk_mul_f32 v[186:187], v[186:187], v[16:17] op_sel_hi:[1,0]
    v_pk_mul_f32 v[188:189], v[188:189], v[16:17] op_sel_hi:[1,0]
    buffer_load_dwordx4 v3, s[16:19], s25 offen offset:1024 sc1 lds
    v_pk_mul_f32 v[190:191], v[190:191], v[16:17] op_sel_hi:[1,0]
    v_cvt_pk_bf16_f32 v84, v180, v181
    v_cvt_pk_bf16_f32 v85, v182, v183
    v_cvt_pk_bf16_f32 v86, v184, v185
    v_cvt_pk_bf16_f32 v87, v186, v187
    v_cvt_pk_bf16_f32 v92, v188, v189
    v_cvt_pk_bf16_f32 v93, v190, v191
    s_waitcnt vmcnt(20)
    v_mfma_f32_32x32x16_bf16 v[180:195], v[52:55], a[20:23], 0
    buffer_load_dwordx4 v3, s[16:19], s25 offen offset:2048 sc1 lds
    v_cndmask_b32 v18, v204, v208, s[36:37]
    v_add_f32 v18, s38, v18
    v_rcp_f32 v18, v18
    s_nop 0
    v_pk_mul_f32 v[196:197], v[196:197], v[18:19] op_sel_hi:[1,0]
    v_pk_mul_f32 v[198:199], v[198:199], v[18:19] op_sel_hi:[1,0]
    v_pk_mul_f32 v[200:201], v[200:201], v[18:19] op_sel_hi:[1,0]
    v_pk_mul_f32 v[202:203], v[202:203], v[18:19] op_sel_hi:[1,0]
    v_pk_mul_f32 v[204:205], v[204:205], v[18:19] op_sel_hi:[1,0]
    buffer_load_dwordx4 v3, s[16:19], s25 offen offset:3072 sc1 lds
    s_add_u32 s25, s25, 4096
    s_waitcnt vmcnt(21)
    v_mfma_f32_32x32x16_bf16 v[180:195], v[56:59], a[24:27], v[180:195]
    v_pk_mul_f32 v[206:207], v[206:207], v[18:19] op_sel_hi:[1,0]
    v_cvt_pk_bf16_f32 v88, v196, v197
    v_cvt_pk_bf16_f32 v89, v198, v199
    v_cvt_pk_bf16_f32 v90, v200, v201
    v_cvt_pk_bf16_f32 v91, v202, v203
    v_cvt_pk_bf16_f32 v196, v204, v205
    v_cvt_pk_bf16_f32 v197, v206, v207
    s_add_u32 m0, s24, 4096
    s_nop 0
    buffer_load_dwordx4 v3, s[16:19], s25 offen offset:0 sc1 lds
    v_cndmask_b32 v92, v92, v196, s[36:37]
    v_cndmask_b32 v93, v93, v197, s[36:37]
    v_mfma_f32_32x32x16_bf16 v[196:211], v[60:63], a[24:27], 0
    v_cndmask_b32 v16, v224, v220, s[36:37]
    v_add_f32 v16, s38, v16
    v_rcp_f32 v16, v16
    s_nop 0
    s_waitcnt vmcnt(21)
    v_mfma_f32_32x32x16_bf16 v[196:211], v[64:67], a[28:31], v[196:211]
    buffer_load_dwordx4 v3, s[16:19], s25 offen offset:1024 sc1 lds
    v_pk_mul_f32 v[212:213], v[212:213], v[16:17] op_sel_hi:[1,0]
    v_pk_mul_f32 v[214:215], v[214:215], v[16:17] op_sel_hi:[1,0]
    v_pk_mul_f32 v[216:217], v[216:217], v[16:17] op_sel_hi:[1,0]
    v_pk_mul_f32 v[218:219], v[218:219], v[16:17] op_sel_hi:[1,0]
    v_mfma_f32_32x32x16_bf16 v[20:35], a[160:163], v[84:87], 0
    v_pk_mul_f32 v[220:221], v[220:221], v[16:17] op_sel_hi:[1,0]
    v_pk_mul_f32 v[222:223], v[222:223], v[16:17] op_sel_hi:[1,0]
    v_cvt_pk_bf16_f32 v94, v212, v213
    v_cvt_pk_bf16_f32 v95, v214, v215
    buffer_load_dwordx4 v3, s[16:19], s25 offen offset:2048 sc1 lds
    v_mfma_f32_32x32x16_bf16 v[36:51], a[164:167], v[84:87], 0
    v_cvt_pk_bf16_f32 v96, v216, v217
    v_cvt_pk_bf16_f32 v97, v218, v219
    v_cvt_pk_bf16_f32 v102, v220, v221
    v_cvt_pk_bf16_f32 v103, v222, v223
    v_mfma_f32_32x32x16_bf16 v[124:139], a[168:171], v[84:87], 0
    buffer_load_dwordx4 v3, s[16:19], s25 offen offset:3072 sc1 lds
    s_add_u32 s25, s25, 4096
    v_cndmask_b32 v18, v236, v240, s[36:37]
    v_add_f32 v18, s38, v18
    v_rcp_f32 v18, v18
    s_nop 0
    v_mfma_f32_32x32x16_bf16 v[140:155], a[172:175], v[84:87], 0
    v_pk_mul_f32 v[228:229], v[228:229], v[18:19] op_sel_hi:[1,0]
    v_pk_mul_f32 v[230:231], v[230:231], v[18:19] op_sel_hi:[1,0]
    v_pk_mul_f32 v[232:233], v[232:233], v[18:19] op_sel_hi:[1,0]
    s_add_u32 m0, s24, 8192
    s_nop 0
    buffer_load_dwordx4 v3, s[16:19], s25 offen offset:0 sc1 lds
    v_pk_mul_f32 v[234:235], v[234:235], v[18:19] op_sel_hi:[1,0]
    v_mfma_f32_32x32x16_bf16 v[156:171], a[176:179], v[84:87], 0
    v_pk_mul_f32 v[236:237], v[236:237], v[18:19] op_sel_hi:[1,0]
    v_pk_mul_f32 v[238:239], v[238:239], v[18:19] op_sel_hi:[1,0]
    v_cvt_pk_bf16_f32 v98, v228, v229
    v_cvt_pk_bf16_f32 v99, v230, v231
    v_mfma_f32_32x32x16_bf16 v[20:35], a[180:183], v[88:91], v[20:35]
    buffer_load_dwordx4 v3, s[16:19], s25 offen offset:1024 sc1 lds
    v_cvt_pk_bf16_f32 v100, v232, v233
    v_cvt_pk_bf16_f32 v101, v234, v235
    v_cvt_pk_bf16_f32 v228, v236, v237
    v_cvt_pk_bf16_f32 v229, v238, v239
    v_mfma_f32_32x32x16_bf16 v[36:51], a[184:187], v[88:91], v[36:51]
    v_cndmask_b32 v102, v102, v228, s[36:37]
    v_cndmask_b32 v103, v103, v229, s[36:37]
    v_mfma_f32_32x32x16_bf16 v[124:139], a[188:191], v[88:91], v[124:139]
    buffer_load_dwordx4 v3, s[16:19], s25 offen offset:2048 sc1 lds
    v_mfma_f32_32x32x16_bf16 v[140:155], a[192:195], v[88:91], v[140:155]
    v_mfma_f32_32x32x16_bf16 v[156:171], a[196:199], v[88:91], v[156:171]
    buffer_load_dwordx4 v3, s[16:19], s25 offen offset:3072 sc1 lds
    s_add_u32 s25, s25, 4096
    v_mfma_f32_32x32x16_bf16 v[212:227], v[68:71], a[28:31], 0
    v_cndmask_b32 v16, v192, v188, s[36:37]
    v_add_f32 v16, s38, v16
    v_rcp_f32 v16, v16
    s_waitcnt vmcnt(27)
    v_mfma_f32_32x32x16_bf16 v[212:227], v[72:75], a[32:35], v[212:227]
    s_add_u32 m0, s24, 12288
    s_nop 0
    buffer_load_dwordx4 v3, s[16:19], s25 offen offset:0 sc1 lds
    s_nop 0
    v_pk_mul_f32 v[180:181], v[180:181], v[16:17] op_sel_hi:[1,0]
    v_pk_mul_f32 v[182:183], v[182:183], v[16:17] op_sel_hi:[1,0]
    v_mfma_f32_32x32x16_bf16 v[228:243], v[76:79], a[32:35], 0
    v_pk_mul_f32 v[184:185], v[184:185], v[16:17] op_sel_hi:[1,0]
    v_pk_mul_f32 v[186:187], v[186:187], v[16:17] op_sel_hi:[1,0]
    v_pk_mul_f32 v[188:189], v[188:189], v[16:17] op_sel_hi:[1,0]
    s_waitcnt vmcnt(27)
    v_mfma_f32_32x32x16_bf16 v[228:243], v[80:83], a[36:39], v[228:243]
    buffer_load_dwordx4 v3, s[16:19], s25 offen offset:1024 sc1 lds
    v_pk_mul_f32 v[190:191], v[190:191], v[16:17] op_sel_hi:[1,0]
    v_cvt_pk_bf16_f32 v104, v180, v181
    v_cvt_pk_bf16_f32 v105, v182, v183
    v_mfma_f32_32x32x16_bf16 v[20:35], a[200:203], v[92:95], v[20:35]
    v_cvt_pk_bf16_f32 v106, v184, v185
    v_cvt_pk_bf16_f32 v107, v186, v187
    v_cvt_pk_bf16_f32 v112, v188, v189
    v_mfma_f32_32x32x16_bf16 v[36:51], a[204:207], v[92:95], v[36:51]
    buffer_load_dwordx4 v3, s[16:19], s25 offen offset:2048 sc1 lds
    v_cvt_pk_bf16_f32 v113, v190, v191
    v_cndmask_b32 v18, v204, v208, s[36:37]
    v_add_f32 v18, s38, v18
    v_mfma_f32_32x32x16_bf16 v[124:139], a[208:211], v[92:95], v[124:139]
    v_rcp_f32 v18, v18
    s_nop 0
    v_pk_mul_f32 v[196:197], v[196:197], v[18:19] op_sel_hi:[1,0]
    v_mfma_f32_32x32x16_bf16 v[140:155], a[212:215], v[92:95], v[140:155]
    buffer_load_dwordx4 v3, s[16:19], s25 offen offset:3072 sc1 lds
    s_add_u32 s25, s25, 4096
    v_pk_mul_f32 v[198:199], v[198:199], v[18:19] op_sel_hi:[1,0]
    v_pk_mul_f32 v[200:201], v[200:201], v[18:19] op_sel_hi:[1,0]
    v_pk_mul_f32 v[202:203], v[202:203], v[18:19] op_sel_hi:[1,0]
    v_mfma_f32_32x32x16_bf16 v[156:171], a[216:219], v[92:95], v[156:171]
    v_pk_mul_f32 v[204:205], v[204:205], v[18:19] op_sel_hi:[1,0]
    v_pk_mul_f32 v[206:207], v[206:207], v[18:19] op_sel_hi:[1,0]
    v_cvt_pk_bf16_f32 v108, v196, v197
    v_mfma_f32_32x32x16_bf16 v[20:35], a[220:223], v[96:99], v[20:35]
    s_add_u32 m0, s24, 16384
    s_nop 0
    buffer_load_dwordx4 v3, s[16:19], s25 offen offset:0 sc1 lds
    v_cvt_pk_bf16_f32 v109, v198, v199
    v_cvt_pk_bf16_f32 v110, v200, v201
    v_cvt_pk_bf16_f32 v111, v202, v203
    v_mfma_f32_32x32x16_bf16 v[36:51], a[224:227], v[96:99], v[36:51]
    v_cvt_pk_bf16_f32 v196, v204, v205
    v_cvt_pk_bf16_f32 v197, v206, v207
    v_cndmask_b32 v112, v112, v196, s[36:37]
    v_mfma_f32_32x32x16_bf16 v[124:139], a[228:231], v[96:99], v[124:139]
    buffer_load_dwordx4 v3, s[16:19], s25 offen offset:1024 sc1 lds
    v_cndmask_b32 v113, v113, v197, s[36:37]
    v_mfma_f32_32x32x16_bf16 v[140:155], a[232:235], v[96:99], v[140:155]
    v_mfma_f32_32x32x16_bf16 v[156:171], a[236:239], v[96:99], v[156:171]
    buffer_load_dwordx4 v3, s[16:19], s25 offen offset:2048 sc1 lds
    v_mfma_f32_32x32x16_bf16 v[20:35], a[240:243], v[100:103], v[20:35]
    v_mfma_f32_32x32x16_bf16 v[36:51], a[44:47], v[100:103], v[36:51]
    buffer_load_dwordx4 v3, s[16:19], s25 offen offset:3072 sc1 lds
    s_add_u32 s25, s25, 4096
    v_mfma_f32_32x32x16_bf16 v[124:139], a[48:51], v[100:103], v[124:139]
    v_mfma_f32_32x32x16_bf16 v[140:155], a[52:55], v[100:103], v[140:155]
    s_add_u32 m0, s24, 20480
    s_nop 0
    buffer_load_dwordx4 v3, s[16:19], s25 offen offset:0 sc1 lds
    v_mfma_f32_32x32x16_bf16 v[156:171], a[56:59], v[100:103], v[156:171]
    v_mfma_f32_32x32x16_bf16 v[20:35], a[60:63], v[104:107], v[20:35]
    buffer_load_dwordx4 v3, s[16:19], s25 offen offset:1024 sc1 lds
    v_cndmask_b32 v16, v224, v220, s[36:37]
    v_add_f32 v16, s38, v16
    v_rcp_f32 v16, v16
    s_nop 0
    v_mfma_f32_32x32x16_bf16 v[36:51], a[64:67], v[104:107], v[36:51]
    v_pk_mul_f32 v[212:213], v[212:213], v[16:17] op_sel_hi:[1,0]
    v_pk_mul_f32 v[214:215], v[214:215], v[16:17] op_sel_hi:[1,0]
    v_pk_mul_f32 v[216:217], v[216:217], v[16:17] op_sel_hi:[1,0]
    buffer_load_dwordx4 a[160:163], v3, s[16:19], s35 offen offset:0 sc1
    v_pk_mul_f32 v[218:219], v[218:219], v[16:17] op_sel_hi:[1,0]
    v_mfma_f32_32x32x16_bf16 v[124:139], a[68:71], v[104:107], v[124:139]
    v_pk_mul_f32 v[220:221], v[220:221], v[16:17] op_sel_hi:[1,0]
    v_pk_mul_f32 v[222:223], v[222:223], v[16:17] op_sel_hi:[1,0]
    v_cvt_pk_bf16_f32 v114, v212, v213
    v_cvt_pk_bf16_f32 v115, v214, v215
    v_mfma_f32_32x32x16_bf16 v[140:155], a[72:75], v[104:107], v[140:155]
    buffer_load_dwordx4 a[164:167], v3, s[16:19], s35 offen offset:1024 sc1
    v_cvt_pk_bf16_f32 v116, v216, v217
    v_cvt_pk_bf16_f32 v117, v218, v219
    v_cvt_pk_bf16_f32 v122, v220, v221
    v_cvt_pk_bf16_f32 v123, v222, v223
    v_mfma_f32_32x32x16_bf16 v[156:171], a[76:79], v[104:107], v[156:171]
    v_cndmask_b32 v18, v236, v240, s[36:37]
    v_add_f32 v18, s38, v18
    v_rcp_f32 v18, v18
    buffer_load_dwordx4 a[168:171], v3, s[16:19], s35 offen offset:2048 sc1
    s_nop 0
    v_mfma_f32_32x32x16_bf16 v[20:35], a[80:83], v[108:111], v[20:35]
    v_pk_mul_f32 v[228:229], v[228:229], v[18:19] op_sel_hi:[1,0]
    v_pk_mul_f32 v[230:231], v[230:231], v[18:19] op_sel_hi:[1,0]
    v_pk_mul_f32 v[232:233], v[232:233], v[18:19] op_sel_hi:[1,0]
    v_pk_mul_f32 v[234:235], v[234:235], v[18:19] op_sel_hi:[1,0]
    v_mfma_f32_32x32x16_bf16 v[36:51], a[84:87], v[108:111], v[36:51]
    buffer_load_dwordx4 a[172:175], v3, s[16:19], s35 offen offset:3072 sc1
    s_add_u32 s35, s35, 4096
    v_pk_mul_f32 v[236:237], v[236:237], v[18:19] op_sel_hi:[1,0]
    v_pk_mul_f32 v[238:239], v[238:239], v[18:19] op_sel_hi:[1,0]
    v_cvt_pk_bf16_f32 v118, v228, v229
    v_cvt_pk_bf16_f32 v119, v230, v231
    v_mfma_f32_32x32x16_bf16 v[124:139], a[88:91], v[108:111], v[124:139]
    v_cvt_pk_bf16_f32 v120, v232, v233
    v_cvt_pk_bf16_f32 v121, v234, v235
    v_cvt_pk_bf16_f32 v228, v236, v237
    buffer_load_dwordx4 a[176:179], v3, s[16:19], s35 offen offset:0 sc1
    v_cvt_pk_bf16_f32 v229, v238, v239
    v_mfma_f32_32x32x16_bf16 v[140:155], a[92:95], v[108:111], v[140:155]
    v_cndmask_b32 v122, v122, v228, s[36:37]
    v_cndmask_b32 v123, v123, v229, s[36:37]
    v_mfma_f32_32x32x16_bf16 v[156:171], a[96:99], v[108:111], v[156:171]
    buffer_load_dwordx4 a[180:183], v3, s[16:19], s35 offen offset:1024 sc1
    ds_read_b64 v[52:53], v5 offset:0
    ds_read_b64 v[54:55], v5 offset:64
    ds_read_b64 v[56:57], v5 offset:128
    ds_read_b64 v[58:59], v5 offset:192
    ds_read_b64 v[60:61], v5 offset:256
    v_mfma_f32_32x32x16_bf16 v[20:35], a[100:103], v[112:115], v[20:35]
    s_sub_u32 s33, s23, 64
    v_add_u32 v13, s33, v3
    s_sub_u32 s33, s20, 1
    s_and_b32 s33, s33, 3
    buffer_load_dwordx4 a[184:187], v3, s[16:19], s35 offen offset:2048 sc1
    s_mul_i32 s33, s33, 15360
    v_mfma_f32_32x32x16_bf16 v[20:35], a[120:123], v[116:119], v[20:35]
    s_add_u32 s33, s33, 102400
    v_add_u32 v14, s33, v3
    s_sub_u32 s33, s20, 2
    s_and_b32 s33, s33, 3
    s_mul_i32 s33, s33, 15360
    s_waitcnt vmcnt(41)
    v_mfma_f32_32x32x16_bf16 v[20:35], a[140:143], v[120:123], v[20:35]
    buffer_load_dwordx4 a[188:191], v3, s[16:19], s35 offen offset:3072 sc1
    s_add_u32 s35, s35, 4096
    s_add_u32 s33, s33, 107520
    v_add_u32 v15, s33, v3
    s_sub_u32 s33, s20, 3
    s_and_b32 s33, s33, 3
    s_mul_i32 s33, s33, 15360
    v_mfma_f32_32x32x16_bf16 v[36:51], a[104:107], v[112:115], v[36:51]
    s_add_u32 s33, s33, 112640
    v_add_u32 v16, s33, v3
    s_mov_b32 s33, 0xffff0000
    s_waitcnt lgkmcnt(0)
    v_lshlrev_b32 v180, 16, v52
    v_mfma_f32_32x32x16_bf16 v[36:51], a[124:127], v[116:119], v[36:51]
    buffer_load_dwordx4 a[192:195], v3, s[16:19], s35 offen offset:0 sc1
    v_and_b32 v181, s33, v52
    v_lshlrev_b32 v182, 16, v53
    v_and_b32 v183, s33, v53
    v_lshlrev_b32 v184, 16, v54
    v_and_b32 v185, s33, v54
    s_waitcnt vmcnt(42)
    v_mfma_f32_32x32x16_bf16 v[36:51], a[144:147], v[120:123], v[36:51]
    v_lshlrev_b32 v186, 16, v55
    v_and_b32 v187, s33, v55
    buffer_load_dwordx4 a[196:199], v3, s[16:19], s35 offen offset:1024 sc1
    v_lshlrev_b32 v188, 16, v56
    v_and_b32 v189, s33, v56
    v_lshlrev_b32 v190, 16, v57
    ds_write_b128 v13, v[24:27] offset:0
    ds_write_b128 v13, v[28:31] offset:5120
    ds_write_b128 v13, v[32:35] offset:10240
    v_mfma_f32_32x32x16_bf16 v[124:139], a[108:111], v[112:115], v[124:139]
    v_and_b32 v191, s33, v57
    v_lshlrev_b32 v192, 16, v58
    buffer_load_dwordx4 a[200:203], v3, s[16:19], s35 offen offset:2048 sc1
    v_and_b32 v193, s33, v58
    v_lshlrev_b32 v194, 16, v59
    v_and_b32 v195, s33, v59
    v_mfma_f32_32x32x16_bf16 v[124:139], a[128:131], v[116:119], v[124:139]
    v_lshlrev_b32 v196, 16, v60
    v_and_b32 v197, s33, v60
    v_lshlrev_b32 v198, 16, v61
    v_and_b32 v199, s33, v61
    s_waitcnt vmcnt(43)
    v_mfma_f32_32x32x16_bf16 v[124:139], a[148:151], v[120:123], v[124:139]
    buffer_load_dwordx4 a[204:207], v3, s[16:19], s35 offen offset:3072 sc1
    s_add_u32 s35, s35, 4096
    ds_write_b128 v13, v[40:43] offset:1024
    ds_write_b128 v13, v[44:47] offset:6144
    ds_write_b128 v13, v[48:51] offset:11264
    v_mfma_f32_32x32x16_bf16 v[140:155], a[112:115], v[112:115], v[140:155]
    v_mfma_f32_32x32x16_bf16 v[140:155], a[132:135], v[116:119], v[140:155]
    buffer_load_dwordx4 a[208:211], v3, s[16:19], s35 offen offset:0 sc1
    s_waitcnt vmcnt(44)
    v_mfma_f32_32x32x16_bf16 v[140:155], a[152:155], v[120:123], v[140:155]
    s_nop 1
    ds_write_b128 v13, v[128:131] offset:2048
    ds_write_b128 v13, v[132:135] offset:7168
    ds_write_b128 v13, v[136:139] offset:12288
    v_mfma_f32_32x32x16_bf16 v[156:171], a[116:119], v[112:115], v[156:171]
    buffer_load_dwordx4 a[212:215], v3, s[16:19], s35 offen offset:1024 sc1
    s_waitcnt lgkmcnt(0)
    s_barrier
    ds_read_b128 v[52:55], v14 offset:0
    ds_read_b128 v[56:59], v15 offset:0
    buffer_load_dwordx4 a[216:219], v3, s[16:19], s35 offen offset:2048 sc1
    ds_read_b128 v[60:63], v16 offset:0
    ds_read_b128 v[64:67], v14 offset:1024
    ds_read_b128 v[68:71], v15 offset:1024
    ds_read_b128 v[72:75], v16 offset:1024
    ds_read_b128 v[220:223], v14 offset:2048
    ds_read_b128 v[224:227], v15 offset:2048
    ds_read_b128 v[228:231], v16 offset:2048
    v_mfma_f32_32x32x16_bf16 v[156:171], a[136:139], v[116:119], v[156:171]
    ds_write_b128 v13, v[144:147] offset:3072
    buffer_load_dwordx4 a[220:223], v3, s[16:19], s35 offen offset:3072 sc1
    s_add_u32 s35, s35, 4096
    ds_write_b128 v13, v[148:151] offset:8192
    ds_write_b128 v13, v[152:155] offset:13312
    s_waitcnt vmcnt(46)
    v_mfma_f32_32x32x16_bf16 v[156:171], a[156:159], v[120:123], v[156:171]
    s_waitcnt lgkmcnt(9)
    v_pk_add_f32 v[52:53], v[52:53], v[56:57]
    v_pk_add_f32 v[54:55], v[54:55], v[58:59]
    v_pk_add_f32 v[180:181], v[180:181], v[60:61]
    v_pk_add_f32 v[182:183], v[182:183], v[62:63]
    buffer_load_dwordx4 a[224:227], v3, s[16:19], s35 offen offset:0 sc1
    v_pk_add_f32 v[180:181], v[180:181], v[52:53]
    v_pk_add_f32 v[182:183], v[182:183], v[54:55]
    v_pk_add_f32 v[180:181], v[180:181], v[20:21]
    v_pk_add_f32 v[182:183], v[182:183], v[22:23]
    v_cvt_pk_bf16_f32 v24, v180, v181
    v_cvt_pk_bf16_f32 v25, v182, v183
    ds_write_b128 v13, v[160:163] offset:4096
    ds_write_b128 v13, v[164:167] offset:9216
    ds_write_b128 v13, v[168:171] offset:14336
    buffer_load_dwordx4 a[228:231], v3, s[16:19], s35 offen offset:1024 sc1
    s_waitcnt lgkmcnt(9)
    v_pk_add_f32 v[64:65], v[64:65], v[68:69]
    v_pk_add_f32 v[66:67], v[66:67], v[70:71]
    v_pk_add_f32 v[184:185], v[184:185], v[72:73]
    v_pk_add_f32 v[186:187], v[186:187], v[74:75]
    v_pk_add_f32 v[184:185], v[184:185], v[64:65]
    v_pk_add_f32 v[186:187], v[186:187], v[66:67]
    v_pk_add_f32 v[184:185], v[184:185], v[36:37]
    v_pk_add_f32 v[186:187], v[186:187], v[38:39]
    v_cvt_pk_bf16_f32 v26, v184, v185
    v_cvt_pk_bf16_f32 v27, v186, v187
    buffer_load_dwordx4 a[232:235], v3, s[16:19], s35 offen offset:2048 sc1
    v_permlane32_swap_b32 v24, v26
    v_permlane32_swap_b32 v25, v27
    buffer_store_dwordx4 v[24:27], v9, s[16:19], s6 offen sc1
    s_add_u32 s6, s6, 4096
    v_pk_add_f32 v[232:233], v[180:181], v[182:183]
    v_pk_mul_f32 v[234:235], v[180:181], v[180:181]
    v_pk_fma_f32 v[234:235], v[182:183], v[182:183], v[234:235]
    v_pk_add_f32 v[232:233], v[232:233], v[184:185]
    v_pk_fma_f32 v[234:235], v[184:185], v[184:185], v[234:235]
    v_pk_add_f32 v[232:233], v[232:233], v[186:187]
    v_pk_fma_f32 v[234:235], v[186:187], v[186:187], v[234:235]
    s_waitcnt lgkmcnt(0)
    s_barrier
    buffer_load_dwordx4 a[236:239], v3, s[16:19], s35 offen offset:3072 sc1
    s_add_u32 s35, s35, 4096
    ds_read_b128 v[84:87], v14 offset:3072
    ds_read_b128 v[88:91], v15 offset:3072
    ds_read_b128 v[92:95], v16 offset:3072
    ds_read_b128 v[96:99], v14 offset:4096
    ds_read_b128 v[100:103], v15 offset:4096
    ds_read_b128 v[104:107], v16 offset:4096
    v_pk_add_f32 v[220:221], v[220:221], v[224:225]
    v_pk_add_f32 v[222:223], v[222:223], v[226:227]
    v_pk_add_f32 v[188:189], v[188:189], v[228:229]
    buffer_load_dwordx4 a[240:243], v3, s[16:19], s35 offen offset:0 sc1
    v_pk_add_f32 v[190:191], v[190:191], v[230:231]
    v_pk_add_f32 v[188:189], v[188:189], v[220:221]
    v_pk_add_f32 v[190:191], v[190:191], v[222:223]
    v_pk_add_f32 v[188:189], v[188:189], v[124:125]
    v_pk_add_f32 v[190:191], v[190:191], v[126:127]
    v_cvt_pk_bf16_f32 v28, v188, v189
    v_cvt_pk_bf16_f32 v29, v190, v191
    v_pk_add_f32 v[232:233], v[232:233], v[188:189]
    v_pk_fma_f32 v[234:235], v[188:189], v[188:189], v[234:235]
    buffer_load_dwordx4 a[44:47], v3, s[16:19], s35 offen offset:1024 sc1
    v_pk_add_f32 v[232:233], v[232:233], v[190:191]
    v_pk_fma_f32 v[234:235], v[190:191], v[190:191], v[234:235]
    s_waitcnt lgkmcnt(3)
    v_pk_add_f32 v[84:85], v[84:85], v[88:89]
    v_pk_add_f32 v[86:87], v[86:87], v[90:91]
    v_pk_add_f32 v[192:193], v[192:193], v[92:93]
    v_pk_add_f32 v[194:195], v[194:195], v[94:95]
    v_pk_add_f32 v[192:193], v[192:193], v[84:85]
    v_pk_add_f32 v[194:195], v[194:195], v[86:87]
    v_pk_add_f32 v[192:193], v[192:193], v[140:141]
    buffer_load_dwordx4 a[48:51], v3, s[16:19], s35 offen offset:2048 sc1
    v_pk_add_f32 v[194:195], v[194:195], v[142:143]
    v_cvt_pk_bf16_f32 v30, v192, v193
    v_cvt_pk_bf16_f32 v31, v194, v195
    s_nop 0
    v_permlane32_swap_b32 v28, v30
    v_permlane32_swap_b32 v29, v31
    buffer_store_dwordx4 v[28:31], v9, s[16:19], s6 offen sc1
    s_add_u32 s6, s6, 4096
    s_waitcnt lgkmcnt(0)
    v_pk_add_f32 v[96:97], v[96:97], v[100:101]
    v_pk_add_f32 v[98:99], v[98:99], v[102:103]
    v_pk_add_f32 v[196:197], v[196:197], v[104:105]
    v_pk_add_f32 v[198:199], v[198:199], v[106:107]
    v_pk_add_f32 v[196:197], v[196:197], v[96:97]
    v_pk_add_f32 v[198:199], v[198:199], v[98:99]
    v_pk_add_f32 v[196:197], v[196:197], v[156:157]
    v_pk_add_f32 v[198:199], v[198:199], v[158:159]
    buffer_load_dwordx4 a[52:55], v3, s[16:19], s35 offen offset:3072 sc1
    s_add_u32 s35, s35, 4096
    v_cvt_pk_bf16_f32 v32, v196, v197
    v_cvt_pk_bf16_f32 v33, v198, v199
    buffer_store_dwordx2 v[32:33], v8, s[16:19], s6 offen sc1
    v_pk_add_f32 v[232:233], v[232:233], v[192:193]
    v_pk_fma_f32 v[234:235], v[192:193], v[192:193], v[234:235]
    v_pk_add_f32 v[232:233], v[232:233], v[194:195]
    v_pk_fma_f32 v[234:235], v[194:195], v[194:195], v[234:235]
    v_pk_add_f32 v[232:233], v[232:233], v[196:197]
    v_pk_fma_f32 v[234:235], v[196:197], v[196:197], v[234:235]
    v_pk_add_f32 v[232:233], v[232:233], v[198:199]
    v_pk_fma_f32 v[234:235], v[198:199], v[198:199], v[234:235]
    v_add_f32 v16, v232, v233
    v_add_f32 v17, v234, v235
    buffer_load_dwordx4 a[56:59], v3, s[16:19], s35 offen offset:0 sc1
    v_mov_b32 v18, v16
    v_mov_b32 v19, v17
    s_nop 0
    v_permlane32_swap_b32 v16, v18
    v_permlane32_swap_b32 v17, v19
    v_pk_add_f32 v[16:17], v[16:17], v[18:19]
    s_mov_b64 exec, 0xffffffff
    buffer_store_dwordx2 v[16:17], v12, s[16:19], s7 offen sc1
    s_mov_b64 exec, -1
    buffer_load_dwordx4 a[60:63], v3, s[16:19], s35 offen offset:1024 sc1
    buffer_load_dwordx4 a[64:67], v3, s[16:19], s35 offen offset:2048 sc1
    buffer_load_dwordx4 a[68:71], v3, s[16:19], s35 offen offset:3072 sc1
    s_add_u32 s35, s35, 4096
    buffer_load_dwordx4 a[72:75], v3, s[16:19], s35 offen offset:0 sc1
    buffer_load_dwordx4 a[76:79], v3, s[16:19], s35 offen offset:1024 sc1
    buffer_load_dwordx4 a[80:83], v3, s[16:19], s35 offen offset:2048 sc1
    s_waitcnt vmcnt(6)
    s_barrier
    s_cmp_lg_u32 s20, 1
    s_cbranch_scc1 sig6
    v_mov_b32 v7, 0
    s_and_b32 s42, s29, 3
    s_mov_b32 s43, s30
    s_lshl_b32 s42, s42, 7
    s_lshl_b32 s43, s43, 2
    s_add_u32 s42, s42, s43
    s_lshl_b32 s43, s26, 12
    s_add_u32 s42, s42, s43
    s_add_u32 s42, s42, 786432
    v_mov_b32 v6, s44
    s_mov_b64 exec, 1
    buffer_store_dword v6, v7, s[16:19], s42 offen sc1
    s_mov_b64 exec, -1
sig6:
    s_mul_i32 s23, s20, 8192
    s_mul_i32 s25, s27, 122880
    s_add_u32 s25, s25, s23
    s_add_u32 s25, s25, 7430144
    s_add_u32 m0, s23, 90112
    s_nop 0
    buffer_load_dwordx4 v3, s[16:19], s25 offen offset:0 sc1 lds
    buffer_load_dwordx4 v3, s[16:19], s25 offen offset:1024 sc1 lds
    buffer_load_dwordx4 v3, s[16:19], s25 offen offset:2048 sc1 lds
    buffer_load_dwordx4 v3, s[16:19], s25 offen offset:3072 sc1 lds
    s_add_u32 s25, s25, 4096
    s_add_u32 m0, s23, 94208
    s_nop 0
    buffer_load_dwordx4 v3, s[16:19], s25 offen offset:0 sc1 lds
    buffer_load_dwordx4 v3, s[16:19], s25 offen offset:1024 sc1 lds
    buffer_load_dwordx4 v3, s[16:19], s25 offen offset:2048 sc1 lds
    buffer_load_dwordx4 v3, s[16:19], s25 offen offset:3072 sc1 lds
    s_add_u32 s25, s25, 4096
    v_add_f32 v244, v244, v245
    v_add_f32 v244, v244, v246
    v_add_f32 v244, v244, v247
    v_add_f32 v244, v244, v248
    v_add_f32 v244, v244, v249
    v_add_f32 v244, v244, v250
    v_add_f32 v244, v244, v251
    v_lshlrev_b32 v245, 16, v252
    v_lshlrev_b32 v6, 2, v0
    v_add_u32 v6, 122880, v6
    ds_write_b32 v6, v244
    ds_write_b32 v6, v245 offset:1024
    s_mul_i32 s21, s28, 40960
    s_add_u32 s21, s21, 14680064
    v_and_b32 v8, 31, v1
    v_lshrrev_b32 v7, 5, v1
    v_lshlrev_b32 v8, 3, v8
    v_lshl_add_u32 v8, v7, 8, v8
    s_lshl_b32 s33, s28, 12
    s_add_u32 s33, s33, 262144
    v_lshlrev_b32 v14, 4, v7
    v_add_u32 v14, 122880, v14
    v_bfe_u32 v15, v1, 4, 1
    v_mul_u32_u24 v15, 49152, v15
    v_and_b32 v16, 15, v1
    v_lshl_add_u32 v15, v16, 4, v15
    v_lshl_add_u32 v15, v7, 9, v15
    s_mul_i32 s34, s28, 98304
    s_mul_i32 s25, s27, 3072
    s_add_u32 s34, s34, s25
    s_add_u32 s34, s34, 18874368
    buffer_load_dwordx4 a[84:87], v3, s[16:19], s35 offen offset:3072 sc1
    s_add_u32 s35, s35, 4096
    buffer_load_dwordx4 a[88:91], v3, s[16:19], s35 offen offset:0 sc1
    buffer_load_dwordx4 a[92:95], v3, s[16:19], s35 offen offset:1024 sc1
    buffer_load_dwordx4 a[96:99], v3, s[16:19], s35 offen offset:2048 sc1
    buffer_load_dwordx4 a[100:103], v3, s[16:19], s35 offen offset:3072 sc1
    s_add_u32 s35, s35, 4096
    buffer_load_dwordx4 a[104:107], v3, s[16:19], s35 offen offset:0 sc1
    s_waitcnt vmcnt(6) lgkmcnt(0)
    s_barrier
    v_and_b32 v11, 3, v1
    v_lshlrev_b32 v11, 2, v11
    s_lshl_b32 s42, s26, 5
    s_add_u32 s42, s42, s20
    s_lshl_b32 s42, s42, 7
    s_add_u32 s42, s42, 786432
    s_mov_b32 s43, 0x20000
poll5:
    buffer_load_dword v10, v11, s[16:19], s42 offen sc1
    s_waitcnt vmcnt(0)
    v_cmp_ne_u32 vcc, s44, v10
    s_cbranch_vccz poll5d
    s_sleep 8
    s_sub_u32 s43, s43, 1
    s_cbranch_scc0 poll5
poll5d:
    buffer_load_dwordx4 v[124:127], v3, s[16:19], s21 offen offset:0 sc1
    buffer_load_dwordx4 v[128:131], v3, s[16:19], s21 offen offset:1024 sc1
    buffer_load_dwordx4 v[132:135], v3, s[16:19], s21 offen offset:2048 sc1
    buffer_load_dwordx4 v[136:139], v3, s[16:19], s21 offen offset:3072 sc1
    s_add_u32 s21, s21, 4096
    buffer_load_dwordx4 v[140:143], v3, s[16:19], s21 offen offset:0 sc1
    buffer_load_dwordx4 v[144:147], v3, s[16:19], s21 offen offset:1024 sc1
    ds_read_b128 v[88:91], v3 offset:0
    ds_read_b128 v[92:95], v3 offset:1024
    ds_read_b128 v[96:99], v3 offset:2048
    ds_read_b128 v[100:103], v3 offset:3072
    ds_read_b128 v[104:107], v3 offset:4096
    ds_read_b128 v[108:111], v3 offset:5120
    s_waitcnt vmcnt(5) lgkmcnt(3)
    v_mfma_f32_32x32x16_bf16 v[40:55], v[88:91], v[124:127], 0
    buffer_load_dwordx4 v[148:151], v3, s[16:19], s21 offen offset:2048 sc1
    ds_read_b128 v[112:115], v3 offset:6144
    v_mfma_f32_32x32x16_bf16 v[56:71], v[92:95], v[124:127], 0
    buffer_load_dwordx4 v[152:155], v3, s[16:19], s21 offen offset:3072 sc1
    s_add_u32 s21, s21, 4096
    ds_read_b128 v[116:119], v3 offset:7168
    v_mfma_f32_32x32x16_bf16 v[72:87], v[96:99], v[124:127], 0
    ds_read_b128 v[120:123], v3 offset:8192
    s_waitcnt vmcnt(6) lgkmcnt(3)
    v_mfma_f32_32x32x16_bf16 v[40:55], v[100:103], v[128:131], v[40:55]
    buffer_load_dwordx4 v[156:159], v3, s[16:19], s21 offen offset:0 sc1
    ds_read_b128 v[88:91], v3 offset:9216
    v_mfma_f32_32x32x16_bf16 v[56:71], v[104:107], v[128:131], v[56:71]
    buffer_load_dwordx4 v[160:163], v3, s[16:19], s21 offen offset:1024 sc1
    ds_read_b128 v[92:95], v3 offset:10240
    v_mfma_f32_32x32x16_bf16 v[72:87], v[108:111], v[128:131], v[72:87]
    ds_read_b128 v[96:99], v3 offset:11264
    s_waitcnt vmcnt(7) lgkmcnt(3)
    v_mfma_f32_32x32x16_bf16 v[40:55], v[112:115], v[132:135], v[40:55]
    buffer_load_dwordx4 v[164:167], v3, s[16:19], s21 offen offset:2048 sc1
    ds_read_b128 v[100:103], v3 offset:12288
    v_mfma_f32_32x32x16_bf16 v[56:71], v[116:119], v[132:135], v[56:71]
    buffer_load_dwordx4 v[168:171], v3, s[16:19], s21 offen offset:3072 sc1
    s_add_u32 s21, s21, 4096
    ds_read_b128 v[104:107], v3 offset:13312
    v_mfma_f32_32x32x16_bf16 v[72:87], v[120:123], v[132:135], v[72:87]
    ds_read_b128 v[108:111], v3 offset:14336
    s_waitcnt vmcnt(8) lgkmcnt(3)
    v_mfma_f32_32x32x16_bf16 v[40:55], v[88:91], v[136:139], v[40:55]
    buffer_load_dwordx4 v[124:127], v3, s[16:19], s21 offen offset:0 sc1
    ds_read_b128 v[112:115], v3 offset:15360
    v_mfma_f32_32x32x16_bf16 v[56:71], v[92:95], v[136:139], v[56:71]
    buffer_load_dwordx4 v[128:131], v3, s[16:19], s21 offen offset:1024 sc1
    ds_read_b128 v[116:119], v3 offset:16384
    v_mfma_f32_32x32x16_bf16 v[72:87], v[96:99], v[136:139], v[72:87]
    ds_read_b128 v[120:123], v3 offset:17408
    s_waitcnt vmcnt(9) lgkmcnt(3)
    v_mfma_f32_32x32x16_bf16 v[40:55], v[100:103], v[140:143], v[40:55]
    buffer_load_dwordx4 v[132:135], v3, s[16:19], s21 offen offset:2048 sc1
    ds_read_b128 v[88:91], v3 offset:18432
    v_mfma_f32_32x32x16_bf16 v[56:71], v[104:107], v[140:143], v[56:71]
    ds_read_b128 v[92:95], v3 offset:19456
    v_mfma_f32_32x32x16_bf16 v[72:87], v[108:111], v[140:143], v[72:87]
    ds_read_b128 v[96:99], v3 offset:20480
    s_waitcnt vmcnt(9) lgkmcnt(3)
    v_mfma_f32_32x32x16_bf16 v[40:55], v[112:115], v[144:147], v[40:55]
    buffer_load_dwordx4 v[136:139], v3, s[16:19], s21 offen offset:3072 sc1
    s_add_u32 s21, s21, 4096
    ds_read_b128 v[100:103], v3 offset:21504
    v_mfma_f32_32x32x16_bf16 v[56:71], v[116:119], v[144:147], v[56:71]
    ds_read_b128 v[104:107], v3 offset:22528
    v_mfma_f32_32x32x16_bf16 v[72:87], v[120:123], v[144:147], v[72:87]
    ds_read_b128 v[108:111], v3 offset:23552
    s_waitcnt vmcnt(9) lgkmcnt(3)
    v_mfma_f32_32x32x16_bf16 v[40:55], v[88:91], v[148:151], v[40:55]
    buffer_load_dwordx4 v[140:143], v3, s[16:19], s21 offen offset:0 sc1
    ds_read_b128 v[112:115], v3 offset:24576
    v_mfma_f32_32x32x16_bf16 v[56:71], v[92:95], v[148:151], v[56:71]
    ds_read_b128 v[116:119], v3 offset:25600
    v_mfma_f32_32x32x16_bf16 v[72:87], v[96:99], v[148:151], v[72:87]
    ds_read_b128 v[120:123], v3 offset:26624
    s_waitcnt vmcnt(9) lgkmcnt(3)
    v_mfma_f32_32x32x16_bf16 v[40:55], v[100:103], v[152:155], v[40:55]
    buffer_load_dwordx4 v[144:147], v3, s[16:19], s21 offen offset:1024 sc1
    ds_read_b128 v[88:91], v3 offset:27648
    v_mfma_f32_32x32x16_bf16 v[56:71], v[104:107], v[152:155], v[56:71]
    ds_read_b128 v[92:95], v3 offset:28672
    v_mfma_f32_32x32x16_bf16 v[72:87], v[108:111], v[152:155], v[72:87]
    ds_read_b128 v[96:99], v3 offset:29696
    s_waitcnt vmcnt(9) lgkmcnt(3)
    v_mfma_f32_32x32x16_bf16 v[40:55], v[112:115], v[156:159], v[40:55]
    buffer_load_dwordx4 v[148:151], v3, s[16:19], s21 offen offset:2048 sc1
    ds_read_b128 v[100:103], v3 offset:30720
    v_mfma_f32_32x32x16_bf16 v[56:71], v[116:119], v[156:159], v[56:71]
    ds_read_b128 v[104:107], v3 offset:31744
    v_mfma_f32_32x32x16_bf16 v[72:87], v[120:123], v[156:159], v[72:87]
    ds_read_b128 v[108:111], v3 offset:32768
    s_waitcnt vmcnt(9) lgkmcnt(3)
    v_mfma_f32_32x32x16_bf16 v[40:55], v[88:91], v[160:163], v[40:55]
    buffer_load_dwordx4 v[152:155], v3, s[16:19], s21 offen offset:3072 sc1
    s_add_u32 s21, s21, 4096
    ds_read_b128 v[112:115], v3 offset:33792
    v_mfma_f32_32x32x16_bf16 v[56:71], v[92:95], v[160:163], v[56:71]
    ds_read_b128 v[116:119], v3 offset:34816
    v_mfma_f32_32x32x16_bf16 v[72:87], v[96:99], v[160:163], v[72:87]
    ds_read_b128 v[120:123], v3 offset:35840
    s_waitcnt vmcnt(9) lgkmcnt(3)
    v_mfma_f32_32x32x16_bf16 v[40:55], v[100:103], v[164:167], v[40:55]
    buffer_load_dwordx4 v[156:159], v3, s[16:19], s21 offen offset:0 sc1
    ds_read_b128 v[88:91], v3 offset:36864
    v_mfma_f32_32x32x16_bf16 v[56:71], v[104:107], v[164:167], v[56:71]
    ds_read_b128 v[92:95], v3 offset:37888
    v_mfma_f32_32x32x16_bf16 v[72:87], v[108:111], v[164:167], v[72:87]
    ds_read_b128 v[96:99], v3 offset:38912
    s_waitcnt vmcnt(9) lgkmcnt(3)
    v_mfma_f32_32x32x16_bf16 v[40:55], v[112:115], v[168:171], v[40:55]
    buffer_load_dwordx4 v[160:163], v3, s[16:19], s21 offen offset:1024 sc1
    ds_read_b128 v[100:103], v3 offset:39936
    v_mfma_f32_32x32x16_bf16 v[56:71], v[116:119], v[168:171], v[56:71]
    ds_read_b128 v[104:107], v3 offset:40960
    v_mfma_f32_32x32x16_bf16 v[72:87], v[120:123], v[168:171], v[72:87]
    ds_read_b128 v[108:111], v3 offset:41984
    s_waitcnt vmcnt(9) lgkmcnt(3)
    v_mfma_f32_32x32x16_bf16 v[40:55], v[88:91], v[124:127], v[40:55]
    buffer_load_dwordx4 v[164:167], v3, s[16:19], s21 offen offset:2048 sc1
    ds_read_b128 v[112:115], v3 offset:43008
    v_mfma_f32_32x32x16_bf16 v[56:71], v[92:95], v[124:127], v[56:71]
    ds_read_b128 v[116:119], v3 offset:44032
    v_mfma_f32_32x32x16_bf16 v[72:87], v[96:99], v[124:127], v[72:87]
    ds_read_b128 v[120:123], v3 offset:45056
    s_waitcnt vmcnt(9) lgkmcnt(3)
    v_mfma_f32_32x32x16_bf16 v[40:55], v[100:103], v[128:131], v[40:55]
    buffer_load_dwordx4 v[168:171], v3, s[16:19], s21 offen offset:3072 sc1
    s_add_u32 s21, s21, 4096
    ds_read_b128 v[88:91], v3 offset:46080
    v_mfma_f32_32x32x16_bf16 v[56:71], v[104:107], v[128:131], v[56:71]
    buffer_load_dwordx2 v[20:21], v8, s[16:19], s33 offen offset:0 sc1
    buffer_load_dwordx2 v[22:23], v8, s[16:19], s33 offen offset:512 sc1
    buffer_load_dwordx2 v[24:25], v8, s[16:19], s33 offen offset:1024 sc1
    buffer_load_dwordx2 v[26:27], v8, s[16:19], s33 offen offset:1536 sc1
    buffer_load_dwordx2 v[28:29], v8, s[16:19], s33 offen offset:2048 sc1
    buffer_load_dwordx2 v[30:31], v8, s[16:19], s33 offen offset:2560 sc1
    buffer_load_dwordx2 v[32:33], v8, s[16:19], s33 offen offset:3072 sc1
    buffer_load_dwordx2 v[34:35], v8, s[16:19], s33 offen offset:3584 sc1
    ds_read_b128 v[92:95], v3 offset:47104
    v_mfma_f32_32x32x16_bf16 v[72:87], v[108:111], v[128:131], v[72:87]
    ds_read_b128 v[96:99], v3 offset:48128
    s_waitcnt vmcnt(17) lgkmcnt(3)
    v_mfma_f32_32x32x16_bf16 v[40:55], v[112:115], v[132:135], v[40:55]
    buffer_load_dwordx4 v[124:127], v3, s[16:19], s21 offen offset:0 sc1
    ds_read_b128 v[100:103], v3 offset:49152
    v_mfma_f32_32x32x16_bf16 v[56:71], v[116:119], v[132:135], v[56:71]
    ds_read_b128 v[104:107], v3 offset:50176
    v_mfma_f32_32x32x16_bf16 v[72:87], v[120:123], v[132:135], v[72:87]
    ds_read_b128 v[108:111], v3 offset:51200
    s_waitcnt vmcnt(17) lgkmcnt(3)
    v_mfma_f32_32x32x16_bf16 v[40:55], v[88:91], v[136:139], v[40:55]
    buffer_load_dwordx4 v[128:131], v3, s[16:19], s21 offen offset:1024 sc1
    ds_read_b128 v[112:115], v3 offset:52224
    v_mfma_f32_32x32x16_bf16 v[56:71], v[92:95], v[136:139], v[56:71]
    ds_read_b128 v[116:119], v3 offset:53248
    v_mfma_f32_32x32x16_bf16 v[72:87], v[96:99], v[136:139], v[72:87]
    ds_read_b128 v[120:123], v3 offset:54272
    s_waitcnt vmcnt(17) lgkmcnt(3)
    v_mfma_f32_32x32x16_bf16 v[40:55], v[100:103], v[140:143], v[40:55]
    buffer_load_dwordx4 v[132:135], v3, s[16:19], s21 offen offset:2048 sc1
    ds_read_b128 v[88:91], v3 offset:55296
    v_mfma_f32_32x32x16_bf16 v[56:71], v[104:107], v[140:143], v[56:71]
    ds_read_b128 v[92:95], v3 offset:56320
    s_waitcnt vmcnt(3)
    v_pk_add_f32 v[20:21], v[20:21], v[22:23]
    v_pk_add_f32 v[20:21], v[20:21], v[24:25]
    v_pk_add_f32 v[20:21], v[20:21], v[26:27]
    v_mfma_f32_32x32x16_bf16 v[72:87], v[108:111], v[140:143], v[72:87]
    ds_read_b128 v[96:99], v3 offset:57344
    v_pk_add_f32 v[20:21], v[20:21], v[28:29]
    v_pk_add_f32 v[20:21], v[20:21], v[30:31]
    v_pk_add_f32 v[20:21], v[20:21], v[32:33]
    s_waitcnt lgkmcnt(3)
    v_mfma_f32_32x32x16_bf16 v[40:55], v[112:115], v[144:147], v[40:55]
    buffer_load_dwordx4 v[136:139], v3, s[16:19], s21 offen offset:3072 sc1
    s_add_u32 s21, s21, 4096
    ds_read_b128 v[100:103], v3 offset:58368
    v_pk_add_f32 v[20:21], v[20:21], v[34:35]
    v_mov_b32 v10, v20
    v_mov_b32 v11, v21
    v_mfma_f32_32x32x16_bf16 v[56:71], v[116:119], v[144:147], v[56:71]
    ds_read_b128 v[104:107], v3 offset:59392
    v_permlane32_swap_b32 v20, v10
    v_permlane32_swap_b32 v21, v11
    v_pk_add_f32 v[8:9], v[20:21], v[10:11]
    v_mfma_f32_32x32x16_bf16 v[72:87], v[120:123], v[144:147], v[72:87]
    ds_read_b128 v[108:111], v3 offset:60416
    v_mul_f32 v8, 0x3acccccd, v8
    v_mul_f32 v9, 0x3acccccd, v9
    v_fma_f32 v9, -v8, v8, v9
    s_waitcnt lgkmcnt(3)
    v_mfma_f32_32x32x16_bf16 v[40:55], v[88:91], v[148:151], v[40:55]
    buffer_load_dwordx4 v[140:143], v3, s[16:19], s21 offen offset:0 sc1
    ds_read_b128 v[112:115], v3 offset:61440
    v_max_f32 v9, 0, v9
    v_cvt_pk_bf16_f32 v8, v8, v8
    v_lshlrev_b32 v8, 16, v8
    v_mfma_f32_32x32x16_bf16 v[56:71], v[92:95], v[148:151], v[56:71]
    ds_read_b128 v[116:119], v3 offset:62464
    v_cvt_pk_bf16_f32 v9, v9, v9
    v_lshlrev_b32 v9, 16, v9
    v_add_f32 v9, 0x3727c5ac, v9
    v_mfma_f32_32x32x16_bf16 v[72:87], v[96:99], v[148:151], v[72:87]
    ds_read_b128 v[120:123], v3 offset:63488
    v_cvt_pk_bf16_f32 v9, v9, v9
    v_lshlrev_b32 v9, 16, v9
    v_sqrt_f32 v9, v9
    s_waitcnt lgkmcnt(3)
    v_mfma_f32_32x32x16_bf16 v[40:55], v[100:103], v[152:155], v[40:55]
    buffer_load_dwordx4 v[144:147], v3, s[16:19], s21 offen offset:1024 sc1
    ds_read_b128 v[88:91], v3 offset:64512
    v_cvt_pk_bf16_f32 v9, v9, v9
    v_lshlrev_b32 v9, 16, v9
    v_rcp_f32 v10, v9
    v_mfma_f32_32x32x16_bf16 v[56:71], v[104:107], v[152:155], v[56:71]
    ds_read_b128 v[92:95], v4 offset:0
    v_mul_f32 v12, v8, v10
    v_sub_f32 v12, 0, v12
    v_mfma_f32_32x32x16_bf16 v[72:87], v[108:111], v[152:155], v[72:87]
    ds_read_b128 v[96:99], v4 offset:1024
    s_waitcnt lgkmcnt(3)
    v_mfma_f32_32x32x16_bf16 v[40:55], v[112:115], v[156:159], v[40:55]
    buffer_load_dwordx4 v[148:151], v3, s[16:19], s21 offen offset:2048 sc1
    ds_read_b128 v[100:103], v4 offset:2048
    v_mfma_f32_32x32x16_bf16 v[56:71], v[116:119], v[156:159], v[56:71]
    ds_read_b128 v[104:107], v4 offset:3072
    v_mfma_f32_32x32x16_bf16 v[72:87], v[120:123], v[156:159], v[72:87]
    ds_read_b128 v[108:111], v4 offset:4096
    ds_read_b128 v[172:175], v14 offset:1024
    ds_read_b128 v[20:23], v14 offset:0
    ds_read_b128 v[176:179], v14 offset:1056
    ds_read_b128 v[24:27], v14 offset:32
    ds_read_b128 v[180:183], v14 offset:1088
    ds_read_b128 v[28:31], v14 offset:64
    ds_read_b128 v[184:187], v14 offset:1120
    ds_read_b128 v[32:35], v14 offset:96
    s_waitcnt lgkmcnt(11)
    v_mfma_f32_32x32x16_bf16 v[40:55], v[88:91], v[160:163], v[40:55]
    buffer_load_dwordx4 v[152:155], v3, s[16:19], s21 offen offset:3072 sc1
    s_add_u32 s21, s21, 4096
    ds_read_b128 v[112:115], v4 offset:5120
    v_mfma_f32_32x32x16_bf16 v[56:71], v[92:95], v[160:163], v[56:71]
    ds_read_b128 v[116:119], v4 offset:6144
    v_mfma_f32_32x32x16_bf16 v[72:87], v[96:99], v[160:163], v[72:87]
    ds_read_b128 v[120:123], v4 offset:7168
    s_waitcnt lgkmcnt(11)
    v_mfma_f32_32x32x16_bf16 v[40:55], v[100:103], v[164:167], v[40:55]
    buffer_load_dwordx4 v[156:159], v3, s[16:19], s21 offen offset:0 sc1
    ds_read_b128 v[88:91], v4 offset:8192
    v_mfma_f32_32x32x16_bf16 v[56:71], v[104:107], v[164:167], v[56:71]
    ds_read_b128 v[92:95], v4 offset:9216
    s_waitcnt lgkmcnt(5)
    v_pk_fma_f32 v[172:173], v[20:21], v[12:13], v[172:173] op_sel_hi:[1,0,1]
    v_pk_fma_f32 v[174:175], v[22:23], v[12:13], v[174:175] op_sel_hi:[1,0,1]
    v_pk_fma_f32 v[176:177], v[24:25], v[12:13], v[176:177] op_sel_hi:[1,0,1]
    v_mfma_f32_32x32x16_bf16 v[72:87], v[108:111], v[164:167], v[72:87]
    ds_read_b128 v[96:99], v4 offset:10240
    v_pk_fma_f32 v[178:179], v[26:27], v[12:13], v[178:179] op_sel_hi:[1,0,1]
    v_pk_fma_f32 v[180:181], v[28:29], v[12:13], v[180:181] op_sel_hi:[1,0,1]
    v_pk_fma_f32 v[182:183], v[30:31], v[12:13], v[182:183] op_sel_hi:[1,0,1]
    s_waitcnt lgkmcnt(3)
    v_mfma_f32_32x32x16_bf16 v[40:55], v[112:115], v[168:171], v[40:55]
    buffer_load_dwordx4 v[160:163], v3, s[16:19], s21 offen offset:1024 sc1
    ds_read_b128 v[100:103], v4 offset:11264
    v_pk_fma_f32 v[184:185], v[32:33], v[12:13], v[184:185] op_sel_hi:[1,0,1]
    v_pk_fma_f32 v[186:187], v[34:35], v[12:13], v[186:187] op_sel_hi:[1,0,1]
    v_mfma_f32_32x32x16_bf16 v[56:71], v[116:119], v[168:171], v[56:71]
    ds_read_b128 v[104:107], v4 offset:12288
    v_mfma_f32_32x32x16_bf16 v[72:87], v[120:123], v[168:171], v[72:87]
    ds_read_b128 v[108:111], v4 offset:13312
    s_waitcnt vmcnt(9) lgkmcnt(3)
    v_mfma_f32_32x32x16_bf16 v[40:55], v[88:91], v[124:127], v[40:55]
    buffer_load_dwordx4 v[164:167], v3, s[16:19], s21 offen offset:2048 sc1
    ds_read_b128 v[112:115], v4 offset:14336
    ds_read_b128 v[188:191], v14 offset:1152
    ds_read_b128 v[20:23], v14 offset:128
    ds_read_b128 v[192:195], v14 offset:1184
    ds_read_b128 v[24:27], v14 offset:160
    ds_read_b128 v[196:199], v14 offset:1216
    ds_read_b128 v[28:31], v14 offset:192
    ds_read_b128 v[200:203], v14 offset:1248
    ds_read_b128 v[32:35], v14 offset:224
    v_mfma_f32_32x32x16_bf16 v[56:71], v[92:95], v[124:127], v[56:71]
    ds_read_b128 v[116:119], v4 offset:15360
    v_mfma_f32_32x32x16_bf16 v[72:87], v[96:99], v[124:127], v[72:87]
    ds_read_b128 v[120:123], v4 offset:16384
    s_waitcnt vmcnt(9) lgkmcnt(11)
    v_mfma_f32_32x32x16_bf16 v[40:55], v[100:103], v[128:131], v[40:55]
    buffer_load_dwordx4 v[168:171], v3, s[16:19], s21 offen offset:3072 sc1
    s_add_u32 s21, s21, 4096
    ds_read_b128 v[88:91], v4 offset:17408
    v_mfma_f32_32x32x16_bf16 v[56:71], v[104:107], v[128:131], v[56:71]
    ds_read_b128 v[92:95], v4 offset:18432
    v_mfma_f32_32x32x16_bf16 v[72:87], v[108:111], v[128:131], v[72:87]
    ds_read_b128 v[96:99], v4 offset:19456
    s_waitcnt lgkmcnt(5)
    v_pk_fma_f32 v[188:189], v[20:21], v[12:13], v[188:189] op_sel_hi:[1,0,1]
    v_pk_fma_f32 v[190:191], v[22:23], v[12:13], v[190:191] op_sel_hi:[1,0,1]
    v_pk_fma_f32 v[192:193], v[24:25], v[12:13], v[192:193] op_sel_hi:[1,0,1]
    s_waitcnt vmcnt(9) lgkmcnt(3)
    v_mfma_f32_32x32x16_bf16 v[40:55], v[112:115], v[132:135], v[40:55]
    buffer_load_dwordx4 v[124:127], v3, s[16:19], s21 offen offset:0 sc1
    ds_read_b128 v[100:103], v4 offset:20480
    v_pk_fma_f32 v[194:195], v[26:27], v[12:13], v[194:195] op_sel_hi:[1,0,1]
    v_pk_fma_f32 v[196:197], v[28:29], v[12:13], v[196:197] op_sel_hi:[1,0,1]
    v_pk_fma_f32 v[198:199], v[30:31], v[12:13], v[198:199] op_sel_hi:[1,0,1]
    v_mfma_f32_32x32x16_bf16 v[56:71], v[116:119], v[132:135], v[56:71]
    ds_read_b128 v[104:107], v4 offset:21504
    v_pk_fma_f32 v[200:201], v[32:33], v[12:13], v[200:201] op_sel_hi:[1,0,1]
    v_pk_fma_f32 v[202:203], v[34:35], v[12:13], v[202:203] op_sel_hi:[1,0,1]
    v_mfma_f32_32x32x16_bf16 v[72:87], v[120:123], v[132:135], v[72:87]
    ds_read_b128 v[108:111], v4 offset:22528
    s_waitcnt vmcnt(9) lgkmcnt(3)
    v_mfma_f32_32x32x16_bf16 v[40:55], v[88:91], v[136:139], v[40:55]
    buffer_load_dwordx4 v[128:131], v3, s[16:19], s21 offen offset:1024 sc1
    ds_read_b128 v[112:115], v4 offset:23552
    v_mfma_f32_32x32x16_bf16 v[56:71], v[92:95], v[136:139], v[56:71]
    ds_read_b128 v[116:119], v4 offset:24576
    ds_read_b128 v[204:207], v14 offset:1280
    ds_read_b128 v[20:23], v14 offset:256
    ds_read_b128 v[208:211], v14 offset:1312
    ds_read_b128 v[24:27], v14 offset:288
    ds_read_b128 v[212:215], v14 offset:1344
    ds_read_b128 v[28:31], v14 offset:320
    ds_read_b128 v[216:219], v14 offset:1376
    ds_read_b128 v[32:35], v14 offset:352
    v_mfma_f32_32x32x16_bf16 v[72:87], v[96:99], v[136:139], v[72:87]
    ds_read_b128 v[120:123], v4 offset:25600
    s_waitcnt vmcnt(9) lgkmcnt(11)
    v_mfma_f32_32x32x16_bf16 v[40:55], v[100:103], v[140:143], v[40:55]
    buffer_load_dwordx4 v[132:135], v3, s[16:19], s21 offen offset:2048 sc1
    ds_read_b128 v[88:91], v4 offset:26624
    v_mfma_f32_32x32x16_bf16 v[56:71], v[104:107], v[140:143], v[56:71]
    ds_read_b128 v[92:95], v4 offset:27648
    v_mfma_f32_32x32x16_bf16 v[72:87], v[108:111], v[140:143], v[72:87]
    ds_read_b128 v[96:99], v4 offset:28672
    s_waitcnt vmcnt(9) lgkmcnt(3)
    v_mfma_f32_32x32x16_bf16 v[40:55], v[112:115], v[144:147], v[40:55]
    buffer_load_dwordx4 v[136:139], v3, s[16:19], s21 offen offset:3072 sc1
    s_add_u32 s21, s21, 4096
    ds_read_b128 v[100:103], v4 offset:29696
    v_pk_fma_f32 v[204:205], v[20:21], v[12:13], v[204:205] op_sel_hi:[1,0,1]
    v_pk_fma_f32 v[206:207], v[22:23], v[12:13], v[206:207] op_sel_hi:[1,0,1]
    v_pk_fma_f32 v[208:209], v[24:25], v[12:13], v[208:209] op_sel_hi:[1,0,1]
    v_mfma_f32_32x32x16_bf16 v[56:71], v[116:119], v[144:147], v[56:71]
    ds_read_b128 v[104:107], v4 offset:30720
    v_pk_fma_f32 v[210:211], v[26:27], v[12:13], v[210:211] op_sel_hi:[1,0,1]
    v_pk_fma_f32 v[212:213], v[28:29], v[12:13], v[212:213] op_sel_hi:[1,0,1]
    v_pk_fma_f32 v[214:215], v[30:31], v[12:13], v[214:215] op_sel_hi:[1,0,1]
    v_mfma_f32_32x32x16_bf16 v[72:87], v[120:123], v[144:147], v[72:87]
    ds_read_b128 v[108:111], v4 offset:31744
    v_pk_fma_f32 v[216:217], v[32:33], v[12:13], v[216:217] op_sel_hi:[1,0,1]
    v_pk_fma_f32 v[218:219], v[34:35], v[12:13], v[218:219] op_sel_hi:[1,0,1]
    s_waitcnt vmcnt(9) lgkmcnt(3)
    v_mfma_f32_32x32x16_bf16 v[40:55], v[88:91], v[148:151], v[40:55]
    ds_read_b128 v[112:115], v4 offset:32768
    v_mfma_f32_32x32x16_bf16 v[56:71], v[92:95], v[148:151], v[56:71]
    buffer_load_dwordx4 a[108:111], v3, s[16:19], s35 offen offset:1024 sc1
    ds_read_b128 v[116:119], v4 offset:33792
    v_mfma_f32_32x32x16_bf16 v[72:87], v[96:99], v[148:151], v[72:87]
    ds_read_b128 v[120:123], v4 offset:34816
    s_waitcnt vmcnt(9) lgkmcnt(3)
    v_mfma_f32_32x32x16_bf16 v[40:55], v[100:103], v[152:155], v[40:55]
    ds_read_b128 v[88:91], v4 offset:35840
    v_mfma_f32_32x32x16_bf16 v[56:71], v[104:107], v[152:155], v[56:71]
    ds_read_b128 v[92:95], v4 offset:36864
    v_mfma_f32_32x32x16_bf16 v[72:87], v[108:111], v[152:155], v[72:87]
    buffer_load_dwordx4 a[112:115], v3, s[16:19], s35 offen offset:2048 sc1
    ds_read_b128 v[96:99], v4 offset:37888
    s_waitcnt vmcnt(9) lgkmcnt(3)
    v_mfma_f32_32x32x16_bf16 v[40:55], v[112:115], v[156:159], v[40:55]
    ds_read_b128 v[100:103], v4 offset:38912
    v_mfma_f32_32x32x16_bf16 v[56:71], v[116:119], v[156:159], v[56:71]
    ds_read_b128 v[104:107], v4 offset:41984
    v_mfma_f32_32x32x16_bf16 v[72:87], v[120:123], v[156:159], v[72:87]
    ds_read_b128 v[108:111], v4 offset:45056
    s_waitcnt vmcnt(8) lgkmcnt(3)
    v_mfma_f32_32x32x16_bf16 v[40:55], v[88:91], v[160:163], v[40:55]
    buffer_load_dwordx4 a[116:119], v3, s[16:19], s35 offen offset:3072 sc1
    s_add_u32 s35, s35, 4096
    ds_read_b128 v[112:115], v4 offset:48128
    v_mfma_f32_32x32x16_bf16 v[56:71], v[92:95], v[160:163], v[56:71]
    ds_read_b128 v[116:119], v4 offset:51200
    v_mfma_f32_32x32x16_bf16 v[72:87], v[96:99], v[160:163], v[72:87]
    ds_read_b128 v[120:123], v4 offset:54272
    s_waitcnt vmcnt(6) lgkmcnt(3)
    v_mfma_f32_32x32x16_bf16 v[40:55], v[100:103], v[164:167], v[40:55]
    ds_read_b128 v[88:91], v4 offset:39936
    v_mfma_f32_32x32x16_bf16 v[40:55], v[104:107], v[168:171], v[40:55]
    buffer_load_dwordx4 a[120:123], v3, s[16:19], s35 offen offset:0 sc1
    ds_read_b128 v[92:95], v4 offset:43008
    v_mfma_f32_32x32x16_bf16 v[40:55], v[108:111], v[124:127], v[40:55]
    ds_read_b128 v[96:99], v4 offset:46080
    s_waitcnt vmcnt(4) lgkmcnt(3)
    v_mfma_f32_32x32x16_bf16 v[40:55], v[112:115], v[128:131], v[40:55]
    ds_read_b128 v[100:103], v4 offset:49152
    v_mfma_f32_32x32x16_bf16 v[40:55], v[116:119], v[132:135], v[40:55]
    ds_read_b128 v[104:107], v4 offset:52224
    v_mfma_f32_32x32x16_bf16 v[40:55], v[120:123], v[136:139], v[40:55]
    buffer_load_dwordx4 a[124:127], v3, s[16:19], s35 offen offset:1024 sc1
    ds_read_b128 v[108:111], v4 offset:55296
    s_waitcnt lgkmcnt(3)
    v_mfma_f32_32x32x16_bf16 v[56:71], v[88:91], v[164:167], v[56:71]
    ds_read_b128 v[112:115], v4 offset:40960
    v_mfma_f32_32x32x16_bf16 v[56:71], v[92:95], v[168:171], v[56:71]
    ds_read_b128 v[116:119], v4 offset:44032
    s_nop 4
    v_pk_fma_f32 v[40:41], v[40:41], v[10:11], v[172:173] op_sel_hi:[1,0,1]
    v_pk_fma_f32 v[42:43], v[42:43], v[10:11], v[174:175] op_sel_hi:[1,0,1]
    v_max_f32 v40, 0, v40
    v_max_f32 v41, 0, v41
    v_max_f32 v42, 0, v42
    v_max_f32 v43, 0, v43
    v_pk_mul_f32 v[40:41], v[40:41], v[40:41]
    v_mfma_f32_32x32x16_bf16 v[56:71], v[96:99], v[124:127], v[56:71]
    ds_read_b128 v[120:123], v4 offset:47104
    v_pk_mul_f32 v[42:43], v[42:43], v[42:43]
    v_cvt_pk_bf16_f32 v172, v40, v41
    v_cvt_pk_bf16_f32 v173, v42, v43
    v_pk_fma_f32 v[44:45], v[44:45], v[10:11], v[176:177] op_sel_hi:[1,0,1]
    v_pk_fma_f32 v[46:47], v[46:47], v[10:11], v[178:179] op_sel_hi:[1,0,1]
    v_max_f32 v44, 0, v44
    buffer_load_dwordx4 a[128:131], v3, s[16:19], s35 offen offset:2048 sc1
    v_max_f32 v45, 0, v45
    s_waitcnt lgkmcnt(3)
    v_mfma_f32_32x32x16_bf16 v[56:71], v[100:103], v[128:131], v[56:71]
    ds_read_b128 v[88:91], v4 offset:50176
    v_max_f32 v46, 0, v46
    v_max_f32 v47, 0, v47
    v_pk_mul_f32 v[44:45], v[44:45], v[44:45]
    v_pk_mul_f32 v[46:47], v[46:47], v[46:47]
    v_cvt_pk_bf16_f32 v174, v44, v45
    v_cvt_pk_bf16_f32 v175, v46, v47
    buffer_store_dwordx4 v[172:175], v15, s[16:19], s34 offen offset:0 sc1
    v_mfma_f32_32x32x16_bf16 v[56:71], v[104:107], v[132:135], v[56:71]
    ds_read_b128 v[92:95], v4 offset:53248
    v_pk_fma_f32 v[48:49], v[48:49], v[10:11], v[180:181] op_sel_hi:[1,0,1]
    v_pk_fma_f32 v[50:51], v[50:51], v[10:11], v[182:183] op_sel_hi:[1,0,1]
    v_max_f32 v48, 0, v48
    v_max_f32 v49, 0, v49
    v_max_f32 v50, 0, v50
    v_max_f32 v51, 0, v51
    v_pk_mul_f32 v[48:49], v[48:49], v[48:49]
    v_mfma_f32_32x32x16_bf16 v[56:71], v[108:111], v[136:139], v[56:71]
    ds_read_b128 v[96:99], v4 offset:56320
    v_pk_mul_f32 v[50:51], v[50:51], v[50:51]
    v_cvt_pk_bf16_f32 v180, v48, v49
    v_cvt_pk_bf16_f32 v181, v50, v51
    v_pk_fma_f32 v[52:53], v[52:53], v[10:11], v[184:185] op_sel_hi:[1,0,1]
    v_pk_fma_f32 v[54:55], v[54:55], v[10:11], v[186:187] op_sel_hi:[1,0,1]
    v_max_f32 v52, 0, v52
    v_max_f32 v53, 0, v53
    s_waitcnt lgkmcnt(3)
    v_mfma_f32_32x32x16_bf16 v[72:87], v[112:115], v[164:167], v[72:87]
    v_max_f32 v54, 0, v54
    buffer_load_dwordx4 a[132:135], v3, s[16:19], s35 offen offset:3072 sc1
    s_add_u32 s35, s35, 4096
    v_max_f32 v55, 0, v55
    v_pk_mul_f32 v[52:53], v[52:53], v[52:53]
    v_pk_mul_f32 v[54:55], v[54:55], v[54:55]
    v_cvt_pk_bf16_f32 v182, v52, v53
    v_cvt_pk_bf16_f32 v183, v54, v55
    buffer_store_dwordx4 v[180:183], v15, s[16:19], s34 offen offset:256 sc1
    v_mfma_f32_32x32x16_bf16 v[72:87], v[116:119], v[168:171], v[72:87]
    v_pk_fma_f32 v[56:57], v[56:57], v[10:11], v[188:189] op_sel_hi:[1,0,1]
    v_pk_fma_f32 v[58:59], v[58:59], v[10:11], v[190:191] op_sel_hi:[1,0,1]
    v_max_f32 v56, 0, v56
    v_max_f32 v57, 0, v57
    v_max_f32 v58, 0, v58
    v_max_f32 v59, 0, v59
    v_pk_mul_f32 v[56:57], v[56:57], v[56:57]
    v_mfma_f32_32x32x16_bf16 v[72:87], v[120:123], v[124:127], v[72:87]
    v_pk_mul_f32 v[58:59], v[58:59], v[58:59]
    v_cvt_pk_bf16_f32 v188, v56, v57
    v_cvt_pk_bf16_f32 v189, v58, v59
    v_pk_fma_f32 v[60:61], v[60:61], v[10:11], v[192:193] op_sel_hi:[1,0,1]
    v_pk_fma_f32 v[62:63], v[62:63], v[10:11], v[194:195] op_sel_hi:[1,0,1]
    v_max_f32 v60, 0, v60
    v_max_f32 v61, 0, v61
    s_waitcnt lgkmcnt(0)
    v_mfma_f32_32x32x16_bf16 v[72:87], v[88:91], v[128:131], v[72:87]
    v_max_f32 v62, 0, v62
    v_max_f32 v63, 0, v63
    v_pk_mul_f32 v[60:61], v[60:61], v[60:61]
    buffer_load_dwordx4 a[136:139], v3, s[16:19], s35 offen offset:0 sc1
    v_pk_mul_f32 v[62:63], v[62:63], v[62:63]
    v_cvt_pk_bf16_f32 v190, v60, v61
    v_cvt_pk_bf16_f32 v191, v62, v63
    buffer_store_dwordx4 v[188:191], v15, s[16:19], s34 offen offset:1024 sc1
    v_mfma_f32_32x32x16_bf16 v[72:87], v[92:95], v[132:135], v[72:87]
    v_mfma_f32_32x32x16_bf16 v[72:87], v[96:99], v[136:139], v[72:87]
    v_pk_fma_f32 v[64:65], v[64:65], v[10:11], v[196:197] op_sel_hi:[1,0,1]
    v_pk_fma_f32 v[66:67], v[66:67], v[10:11], v[198:199] op_sel_hi:[1,0,1]
    v_max_f32 v64, 0, v64
    v_max_f32 v65, 0, v65
    v_max_f32 v66, 0, v66
    v_max_f32 v67, 0, v67
    v_pk_mul_f32 v[64:65], v[64:65], v[64:65]
    v_pk_mul_f32 v[66:67], v[66:67], v[66:67]
    v_cvt_pk_bf16_f32 v196, v64, v65
    v_cvt_pk_bf16_f32 v197, v66, v67
    v_pk_fma_f32 v[68:69], v[68:69], v[10:11], v[200:201] op_sel_hi:[1,0,1]
    v_pk_fma_f32 v[70:71], v[70:71], v[10:11], v[202:203] op_sel_hi:[1,0,1]
    v_max_f32 v68, 0, v68
    v_max_f32 v69, 0, v69
    v_max_f32 v70, 0, v70
    v_max_f32 v71, 0, v71
    v_pk_mul_f32 v[68:69], v[68:69], v[68:69]
    v_pk_mul_f32 v[70:71], v[70:71], v[70:71]
    v_cvt_pk_bf16_f32 v198, v68, v69
    buffer_load_dwordx4 a[140:143], v3, s[16:19], s35 offen offset:1024 sc1
    v_cvt_pk_bf16_f32 v199, v70, v71
    buffer_store_dwordx4 v[196:199], v15, s[16:19], s34 offen offset:1280 sc1
    v_pk_fma_f32 v[72:73], v[72:73], v[10:11], v[204:205] op_sel_hi:[1,0,1]
    v_pk_fma_f32 v[74:75], v[74:75], v[10:11], v[206:207] op_sel_hi:[1,0,1]
    v_max_f32 v72, 0, v72
    v_max_f32 v73, 0, v73
    v_max_f32 v74, 0, v74
    v_max_f32 v75, 0, v75
    v_pk_mul_f32 v[72:73], v[72:73], v[72:73]
    v_pk_mul_f32 v[74:75], v[74:75], v[74:75]
    v_cvt_pk_bf16_f32 v204, v72, v73
    v_cvt_pk_bf16_f32 v205, v74, v75
    v_pk_fma_f32 v[76:77], v[76:77], v[10:11], v[208:209] op_sel_hi:[1,0,1]
    v_pk_fma_f32 v[78:79], v[78:79], v[10:11], v[210:211] op_sel_hi:[1,0,1]
    v_max_f32 v76, 0, v76
    v_max_f32 v77, 0, v77
    v_max_f32 v78, 0, v78
    v_max_f32 v79, 0, v79
    v_pk_mul_f32 v[76:77], v[76:77], v[76:77]
    v_pk_mul_f32 v[78:79], v[78:79], v[78:79]
    v_cvt_pk_bf16_f32 v206, v76, v77
    v_cvt_pk_bf16_f32 v207, v78, v79
    buffer_store_dwordx4 v[204:207], v15, s[16:19], s34 offen offset:2048 sc1
    v_pk_fma_f32 v[80:81], v[80:81], v[10:11], v[212:213] op_sel_hi:[1,0,1]
    v_pk_fma_f32 v[82:83], v[82:83], v[10:11], v[214:215] op_sel_hi:[1,0,1]
    v_max_f32 v80, 0, v80
    v_max_f32 v81, 0, v81
    v_max_f32 v82, 0, v82
    v_max_f32 v83, 0, v83
    v_pk_mul_f32 v[80:81], v[80:81], v[80:81]
    v_pk_mul_f32 v[82:83], v[82:83], v[82:83]
    v_cvt_pk_bf16_f32 v212, v80, v81
    v_cvt_pk_bf16_f32 v213, v82, v83
    v_pk_fma_f32 v[84:85], v[84:85], v[10:11], v[216:217] op_sel_hi:[1,0,1]
    v_pk_fma_f32 v[86:87], v[86:87], v[10:11], v[218:219] op_sel_hi:[1,0,1]
    v_max_f32 v84, 0, v84
    v_max_f32 v85, 0, v85
    v_max_f32 v86, 0, v86
    v_max_f32 v87, 0, v87
    v_pk_mul_f32 v[84:85], v[84:85], v[84:85]
    v_pk_mul_f32 v[86:87], v[86:87], v[86:87]
    v_cvt_pk_bf16_f32 v214, v84, v85
    v_cvt_pk_bf16_f32 v215, v86, v87
    buffer_store_dwordx4 v[212:215], v15, s[16:19], s34 offen offset:2304 sc1
    buffer_load_dwordx4 a[144:147], v3, s[16:19], s35 offen offset:2048 sc1
    buffer_load_dwordx4 a[148:151], v3, s[16:19], s35 offen offset:3072 sc1
    s_add_u32 s35, s35, 4096
    buffer_load_dwordx4 a[152:155], v3, s[16:19], s35 offen offset:0 sc1
    buffer_load_dwordx4 a[156:159], v3, s[16:19], s35 offen offset:1024 sc1
    buffer_load_dwordx4 a[0:3], v3, s[16:19], s35 offen offset:2048 sc1
    buffer_load_dwordx4 a[4:7], v3, s[16:19], s35 offen offset:3072 sc1
    s_add_u32 s35, s35, 4096
    buffer_load_dwordx4 a[8:11], v3, s[16:19], s35 offen offset:0 sc1
    buffer_load_dwordx4 a[12:15], v3, s[16:19], s35 offen offset:1024 sc1
    s_waitcnt vmcnt(8)
    s_barrier
    s_cmp_lg_u32 s20, 1
    s_cbranch_scc1 sig7
    v_mov_b32 v7, 0
    s_lshr_b32 s42, s27, 2
    s_and_b32 s43, s27, 3
    s_lshl_b32 s42, s42, 7
    s_lshl_b32 s43, s43, 2
    s_add_u32 s42, s42, s43
    s_lshl_b32 s43, s26, 12
    s_add_u32 s42, s42, s43
    s_add_u32 s42, s42, 851968
    v_mov_b32 v6, s44
    s_mov_b64 exec, 1
    buffer_store_dword v6, v7, s[16:19], s42 offen sc1
    s_mov_b64 exec, -1
sig7:
    s_mov_b32 s8, s62
    s_mov_b32 s9, s63
    s_mov_b32 s10, 1280
    s_mov_b32 s11, 0x20000
    v_and_b32 v4, 15, v1
    v_lshrrev_b32 v5, 4, v1
    s_lshl_b32 s33, s12, 1
    s_lshr_b32 s25, s20, 1
    s_add_u32 s33, s33, s25
    s_mul_i32 s33, s33, 40
    s_mul_i32 s25, s13, 5
    s_add_u32 s33, s33, s25
    s_lshl_b32 s33, s33, 10
    s_add_u32 s33, s33, 14680064
    s_and_b32 s25, s20, 1
    s_lshl_b32 s25, s25, 8
    s_add_u32 s33, s33, s25
    v_lshrrev_b32 v8, 1, v5
    v_lshlrev_b32 v8, 9, v8
    v_lshl_add_u32 v8, v4, 4, v8
    v_and_b32 v9, 1, v5
    v_lshl_add_u32 v8, v9, 3, v8
    v_add_u32 v9, 4096, v8
    v_lshlrev_b32 v17, 3, v5
    s_mul_i32 s34, s13, 160
    v_and_b32 v10, 1, v5
    v_mul_u32_u24 v11, 1016, v10
    v_add_u32 v11, v11, v8
    v_mul_u32_u24 v10, 24, v10
    v_add_u32 v10, v10, v17
    buffer_load_dwordx4 v[20:23], v11, s[16:19], s33 offen offset:0 sc1
    buffer_load_dwordx4 v[24:27], v11, s[16:19], s33 offen offset:2048 sc1
    buffer_load_dwordx2 v[28:29], v9, s[16:19], s33 offen sc1
    buffer_load_dwordx4 v[30:33], v10, s[8:11], s34 offen offset:0
    buffer_load_dwordx4 v[34:37], v10, s[8:11], s34 offen offset:64
    buffer_load_dwordx2 v[38:39], v17, s[8:11], s34 offen offset:128
    buffer_load_dwordx4 a[16:19], v3, s[16:19], s35 offen offset:2048 sc1
    buffer_load_dwordx4 a[20:23], v3, s[16:19], s35 offen offset:3072 sc1
    s_add_u32 s35, s35, 4096
    buffer_load_dwordx4 a[24:27], v3, s[16:19], s35 offen offset:0 sc1
    buffer_load_dwordx4 a[28:31], v3, s[16:19], s35 offen offset:1024 sc1
    buffer_load_dwordx4 a[32:35], v3, s[16:19], s35 offen offset:2048 sc1
    buffer_load_dwordx4 a[36:39], v3, s[16:19], s35 offen offset:3072 sc1
    s_add_u32 s35, s35, 4096
    s_mul_i32 s21, s12, 196608
    s_mul_i32 s22, s20, 12288
    s_add_u32 s21, s21, s22
    s_add_u32 s21, s21, 18874368
    s_lshl_b32 s25, s12, 6
    s_lshl_b32 s33, s20, 4
    s_add_u32 s25, s25, s33
    v_add_u32 v6, s25, v4
    v_mul_u32_u24 v7, 1280, v6
    v_and_b32 v6, 1, v5
    v_lshl_add_u32 v6, v6, 5, v7
    v_lshrrev_b32 v12, 1, v5
    v_lshl_add_u32 v6, v12, 4, v6
    v_lshl_add_u32 v7, v5, 3, v7
    s_mul_i32 s33, s20, 15360
    v_add_u32 v13, s33, v3
    s_add_u32 s33, s20, 0
    s_and_b32 s33, s33, 3
    s_mul_i32 s33, s33, 49152
    v_add_u32 v8, s33, v3
    s_add_u32 s33, s20, 1
    s_and_b32 s33, s33, 3
    s_mul_i32 s33, s33, 49152
    v_add_u32 v9, s33, v3
    s_add_u32 s33, s20, 2
    s_and_b32 s33, s33, 3
    s_mul_i32 s33, s33, 49152
    v_add_u32 v10, s33, v3
    s_add_u32 s33, s20, 3
    s_and_b32 s33, s33, 3
    s_mul_i32 s33, s33, 49152
    v_add_u32 v11, s33, v3
    s_sub_u32 s33, s20, 1
    s_and_b32 s33, s33, 3
    s_mul_i32 s33, s33, 15360
    s_add_u32 s33, s33, 0
    v_add_u32 v14, s33, v3
    s_sub_u32 s33, s20, 2
    s_and_b32 s33, s33, 3
    s_mul_i32 s33, s33, 15360
    s_add_u32 s33, s33, 5120
    v_add_u32 v15, s33, v3
    s_sub_u32 s33, s20, 3
    s_and_b32 s33, s33, 3
    s_mul_i32 s33, s33, 15360
    s_add_u32 s33, s33, 10240
    v_add_u32 v16, s33, v3
    s_mov_b32 s8, s46
    s_mov_b32 s9, s47
    s_mov_b32 s10, 2621440
    s_mov_b32 s11, 0x20000
    v_and_b32 v19, 3, v1
    v_lshlrev_b32 v19, 2, v19
    s_lshl_b32 s42, s26, 5
    s_add_u32 s42, s42, s20
    s_lshl_b32 s42, s42, 7
    s_add_u32 s42, s42, 851968
    s_mov_b32 s43, 0x20000
poll6:
    buffer_load_dword v18, v19, s[16:19], s42 offen sc1
    s_waitcnt vmcnt(0)
    v_cmp_ne_u32 vcc, s44, v18
    s_cbranch_vccz poll6d
    s_sleep 8
    s_sub_u32 s43, s43, 1
    s_cbranch_scc0 poll6
poll6d:
    buffer_load_dwordx4 v[120:123], v8, s[16:19], s21 offen offset:0 sc1
    buffer_load_dwordx4 v[124:127], v9, s[16:19], s21 offen offset:0 sc1
    buffer_load_dwordx4 v[128:131], v10, s[16:19], s21 offen offset:0 sc1
    buffer_load_dwordx4 v[132:135], v11, s[16:19], s21 offen offset:0 sc1
    buffer_load_dwordx4 v[136:139], v8, s[16:19], s21 offen offset:1024 sc1
    buffer_load_dwordx4 v[140:143], v9, s[16:19], s21 offen offset:1024 sc1
    buffer_load_dwordx4 v[144:147], v10, s[16:19], s21 offen offset:1024 sc1
    buffer_load_dwordx4 v[148:151], v11, s[16:19], s21 offen offset:1024 sc1
    buffer_load_dwordx4 v[152:155], v8, s[16:19], s21 offen offset:2048 sc1
    buffer_load_dwordx4 v[156:159], v9, s[16:19], s21 offen offset:2048 sc1
    buffer_load_dwordx4 v[160:163], v10, s[16:19], s21 offen offset:2048 sc1
    buffer_load_dwordx4 v[164:167], v11, s[16:19], s21 offen offset:2048 sc1
    s_waitcnt vmcnt(11)
    v_mfma_f32_16x16x32_bf16 v[40:43], a[160:163], v[120:123], 0
    s_mov_b32 s33, 0xffff0000
    v_permlane16_swap_b32 v20, v22
    v_mfma_f32_16x16x32_bf16 v[44:47], a[164:167], v[120:123], 0
    buffer_load_dwordx4 v[168:171], v8, s[16:19], s21 offen offset:3072 sc1
    v_permlane16_swap_b32 v21, v23
    v_permlane16_swap_b32 v24, v26
    v_mfma_f32_16x16x32_bf16 v[48:51], a[168:171], v[120:123], 0
    v_permlane16_swap_b32 v25, v27
    v_permlane16_swap_b32 v30, v32
    v_mfma_f32_16x16x32_bf16 v[52:55], a[172:175], v[120:123], 0
    buffer_load_dwordx4 v[172:175], v9, s[16:19], s21 offen offset:3072 sc1
    v_permlane16_swap_b32 v31, v33
    v_permlane16_swap_b32 v34, v36
    v_mfma_f32_16x16x32_bf16 v[56:59], a[176:179], v[120:123], 0
    v_permlane16_swap_b32 v35, v37
    v_lshlrev_b32 v232, 16, v20
    s_waitcnt vmcnt(12)
    v_mfma_f32_16x16x32_bf16 v[60:63], a[160:163], v[124:127], 0
    v_and_b32 v233, s33, v20
    v_lshlrev_b32 v252, 16, v30
    v_mfma_f32_16x16x32_bf16 v[64:67], a[164:167], v[124:127], 0
    buffer_load_dwordx4 v[176:179], v10, s[16:19], s21 offen offset:3072 sc1
    v_and_b32 v253, s33, v30
    v_pk_add_f32 v[232:233], v[232:233], v[252:253]
    v_mfma_f32_16x16x32_bf16 v[68:71], a[168:171], v[124:127], 0
    v_lshlrev_b32 v234, 16, v21
    v_and_b32 v235, s33, v21
    v_mfma_f32_16x16x32_bf16 v[72:75], a[172:175], v[124:127], 0
    buffer_load_dwordx4 v[180:183], v11, s[16:19], s21 offen offset:3072 sc1
    s_add_u32 s21, s21, 4096
    v_lshlrev_b32 v252, 16, v31
    v_and_b32 v253, s33, v31
    v_mfma_f32_16x16x32_bf16 v[76:79], a[176:179], v[124:127], 0
    v_pk_add_f32 v[234:235], v[234:235], v[252:253]
    v_lshlrev_b32 v236, 16, v22
    s_waitcnt vmcnt(13)
    v_mfma_f32_16x16x32_bf16 v[80:83], a[160:163], v[128:131], 0
    v_and_b32 v237, s33, v22
    v_lshlrev_b32 v252, 16, v32
    v_mfma_f32_16x16x32_bf16 v[84:87], a[164:167], v[128:131], 0
    buffer_load_dwordx4 v[184:187], v8, s[16:19], s21 offen offset:0 sc1
    v_and_b32 v253, s33, v32
    v_pk_add_f32 v[236:237], v[236:237], v[252:253]
    v_mfma_f32_16x16x32_bf16 v[88:91], a[168:171], v[128:131], 0
    v_lshlrev_b32 v238, 16, v23
    v_and_b32 v239, s33, v23
    v_mfma_f32_16x16x32_bf16 v[92:95], a[172:175], v[128:131], 0
    buffer_load_dwordx4 v[188:191], v9, s[16:19], s21 offen offset:0 sc1
    v_lshlrev_b32 v252, 16, v33
    v_and_b32 v253, s33, v33
    v_mfma_f32_16x16x32_bf16 v[96:99], a[176:179], v[128:131], 0
    v_pk_add_f32 v[238:239], v[238:239], v[252:253]
    v_lshlrev_b32 v240, 16, v24
    s_waitcnt vmcnt(14)
    v_mfma_f32_16x16x32_bf16 v[100:103], a[160:163], v[132:135], 0
    v_and_b32 v241, s33, v24
    v_lshlrev_b32 v252, 16, v34
    v_mfma_f32_16x16x32_bf16 v[104:107], a[164:167], v[132:135], 0
    buffer_load_dwordx4 v[192:195], v10, s[16:19], s21 offen offset:0 sc1
    v_and_b32 v253, s33, v34
    v_pk_add_f32 v[240:241], v[240:241], v[252:253]
    v_mfma_f32_16x16x32_bf16 v[108:111], a[168:171], v[132:135], 0
    v_lshlrev_b32 v242, 16, v25
    v_and_b32 v243, s33, v25
    v_mfma_f32_16x16x32_bf16 v[112:115], a[172:175], v[132:135], 0
    buffer_load_dwordx4 v[196:199], v11, s[16:19], s21 offen offset:0 sc1
    v_lshlrev_b32 v252, 16, v35
    v_and_b32 v253, s33, v35
    v_mfma_f32_16x16x32_bf16 v[116:119], a[176:179], v[132:135], 0
    v_pk_add_f32 v[242:243], v[242:243], v[252:253]
    v_lshlrev_b32 v244, 16, v26
    s_waitcnt vmcnt(15)
    v_mfma_f32_16x16x32_bf16 v[40:43], a[180:183], v[136:139], v[40:43]
    v_and_b32 v245, s33, v26
    v_lshlrev_b32 v252, 16, v36
    v_mfma_f32_16x16x32_bf16 v[44:47], a[184:187], v[136:139], v[44:47]
    buffer_load_dwordx4 v[200:203], v8, s[16:19], s21 offen offset:1024 sc1
    v_and_b32 v253, s33, v36
    v_pk_add_f32 v[244:245], v[244:245], v[252:253]
    v_mfma_f32_16x16x32_bf16 v[48:51], a[188:191], v[136:139], v[48:51]
    v_lshlrev_b32 v246, 16, v27
    v_and_b32 v247, s33, v27
    v_mfma_f32_16x16x32_bf16 v[52:55], a[192:195], v[136:139], v[52:55]
    buffer_load_dwordx4 v[204:207], v9, s[16:19], s21 offen offset:1024 sc1
    v_lshlrev_b32 v252, 16, v37
    v_and_b32 v253, s33, v37
    v_mfma_f32_16x16x32_bf16 v[56:59], a[196:199], v[136:139], v[56:59]
    v_pk_add_f32 v[246:247], v[246:247], v[252:253]
    v_lshlrev_b32 v248, 16, v28
    s_waitcnt vmcnt(16)
    v_mfma_f32_16x16x32_bf16 v[60:63], a[180:183], v[140:143], v[60:63]
    v_and_b32 v249, s33, v28
    v_lshlrev_b32 v252, 16, v38
    v_mfma_f32_16x16x32_bf16 v[64:67], a[184:187], v[140:143], v[64:67]
    buffer_load_dwordx4 v[208:211], v10, s[16:19], s21 offen offset:1024 sc1
    v_and_b32 v253, s33, v38
    v_pk_add_f32 v[248:249], v[248:249], v[252:253]
    v_mfma_f32_16x16x32_bf16 v[68:71], a[188:191], v[140:143], v[68:71]
    v_lshlrev_b32 v250, 16, v29
    v_and_b32 v251, s33, v29
    v_mfma_f32_16x16x32_bf16 v[72:75], a[192:195], v[140:143], v[72:75]
    buffer_load_dwordx4 v[212:215], v11, s[16:19], s21 offen offset:1024 sc1
    v_lshlrev_b32 v252, 16, v39
    v_and_b32 v253, s33, v39
    v_mfma_f32_16x16x32_bf16 v[76:79], a[196:199], v[140:143], v[76:79]
    v_pk_add_f32 v[250:251], v[250:251], v[252:253]
    s_waitcnt vmcnt(17)
    v_mfma_f32_16x16x32_bf16 v[80:83], a[180:183], v[144:147], v[80:83]
    v_mfma_f32_16x16x32_bf16 v[84:87], a[184:187], v[144:147], v[84:87]
    buffer_load_dwordx4 v[120:123], v8, s[16:19], s21 offen offset:2048 sc1
    v_mfma_f32_16x16x32_bf16 v[88:91], a[188:191], v[144:147], v[88:91]
    v_mfma_f32_16x16x32_bf16 v[92:95], a[192:195], v[144:147], v[92:95]
    buffer_load_dwordx4 v[124:127], v9, s[16:19], s21 offen offset:2048 sc1
    v_mfma_f32_16x16x32_bf16 v[96:99], a[196:199], v[144:147], v[96:99]
    s_waitcnt vmcnt(18)
    v_mfma_f32_16x16x32_bf16 v[100:103], a[180:183], v[148:151], v[100:103]
    v_mfma_f32_16x16x32_bf16 v[104:107], a[184:187], v[148:151], v[104:107]
    buffer_load_dwordx4 v[128:131], v10, s[16:19], s21 offen offset:2048 sc1
    v_mfma_f32_16x16x32_bf16 v[108:111], a[188:191], v[148:151], v[108:111]
    v_mfma_f32_16x16x32_bf16 v[112:115], a[192:195], v[148:151], v[112:115]
    v_mfma_f32_16x16x32_bf16 v[116:119], a[196:199], v[148:151], v[116:119]
    s_waitcnt vmcnt(18)
    v_mfma_f32_16x16x32_bf16 v[40:43], a[200:203], v[152:155], v[40:43]
    v_mfma_f32_16x16x32_bf16 v[44:47], a[204:207], v[152:155], v[44:47]
    buffer_load_dwordx4 v[132:135], v11, s[16:19], s21 offen offset:2048 sc1
    v_mfma_f32_16x16x32_bf16 v[48:51], a[208:211], v[152:155], v[48:51]
    v_mfma_f32_16x16x32_bf16 v[52:55], a[212:215], v[152:155], v[52:55]
    v_mfma_f32_16x16x32_bf16 v[56:59], a[216:219], v[152:155], v[56:59]
    s_waitcnt vmcnt(18)
    v_mfma_f32_16x16x32_bf16 v[60:63], a[200:203], v[156:159], v[60:63]
    v_mfma_f32_16x16x32_bf16 v[64:67], a[204:207], v[156:159], v[64:67]
    buffer_load_dwordx4 v[136:139], v8, s[16:19], s21 offen offset:3072 sc1
    v_mfma_f32_16x16x32_bf16 v[68:71], a[208:211], v[156:159], v[68:71]
    v_mfma_f32_16x16x32_bf16 v[72:75], a[212:215], v[156:159], v[72:75]
    v_mfma_f32_16x16x32_bf16 v[76:79], a[216:219], v[156:159], v[76:79]
    s_waitcnt vmcnt(18)
    v_mfma_f32_16x16x32_bf16 v[80:83], a[200:203], v[160:163], v[80:83]
    v_mfma_f32_16x16x32_bf16 v[84:87], a[204:207], v[160:163], v[84:87]
    buffer_load_dwordx4 v[140:143], v9, s[16:19], s21 offen offset:3072 sc1
    v_mfma_f32_16x16x32_bf16 v[88:91], a[208:211], v[160:163], v[88:91]
    v_mfma_f32_16x16x32_bf16 v[92:95], a[212:215], v[160:163], v[92:95]
    v_mfma_f32_16x16x32_bf16 v[96:99], a[216:219], v[160:163], v[96:99]
    s_waitcnt vmcnt(18)
    v_mfma_f32_16x16x32_bf16 v[100:103], a[200:203], v[164:167], v[100:103]
    v_mfma_f32_16x16x32_bf16 v[104:107], a[204:207], v[164:167], v[104:107]
    buffer_load_dwordx4 v[144:147], v10, s[16:19], s21 offen offset:3072 sc1
    v_mfma_f32_16x16x32_bf16 v[108:111], a[208:211], v[164:167], v[108:111]
    v_mfma_f32_16x16x32_bf16 v[112:115], a[212:215], v[164:167], v[112:115]
    v_mfma_f32_16x16x32_bf16 v[116:119], a[216:219], v[164:167], v[116:119]
    s_waitcnt vmcnt(18)
    v_mfma_f32_16x16x32_bf16 v[40:43], a[220:223], v[168:171], v[40:43]
    v_mfma_f32_16x16x32_bf16 v[44:47], a[224:227], v[168:171], v[44:47]
    buffer_load_dwordx4 v[148:151], v11, s[16:19], s21 offen offset:3072 sc1
    s_add_u32 s21, s21, 4096
    v_mfma_f32_16x16x32_bf16 v[48:51], a[228:231], v[168:171], v[48:51]
    v_mfma_f32_16x16x32_bf16 v[52:55], a[232:235], v[168:171], v[52:55]
    v_mfma_f32_16x16x32_bf16 v[56:59], a[236:239], v[168:171], v[56:59]
    s_waitcnt vmcnt(18)
    v_mfma_f32_16x16x32_bf16 v[60:63], a[220:223], v[172:175], v[60:63]
    v_mfma_f32_16x16x32_bf16 v[64:67], a[224:227], v[172:175], v[64:67]
    buffer_load_dwordx4 v[152:155], v8, s[16:19], s21 offen offset:0 sc1
    v_mfma_f32_16x16x32_bf16 v[68:71], a[228:231], v[172:175], v[68:71]
    v_mfma_f32_16x16x32_bf16 v[72:75], a[232:235], v[172:175], v[72:75]
    v_mfma_f32_16x16x32_bf16 v[76:79], a[236:239], v[172:175], v[76:79]
    s_waitcnt vmcnt(18)
    v_mfma_f32_16x16x32_bf16 v[80:83], a[220:223], v[176:179], v[80:83]
    v_mfma_f32_16x16x32_bf16 v[84:87], a[224:227], v[176:179], v[84:87]
    buffer_load_dwordx4 v[156:159], v9, s[16:19], s21 offen offset:0 sc1
    v_mfma_f32_16x16x32_bf16 v[88:91], a[228:231], v[176:179], v[88:91]
    v_mfma_f32_16x16x32_bf16 v[92:95], a[232:235], v[176:179], v[92:95]
    v_mfma_f32_16x16x32_bf16 v[96:99], a[236:239], v[176:179], v[96:99]
    s_waitcnt vmcnt(18)
    v_mfma_f32_16x16x32_bf16 v[100:103], a[220:223], v[180:183], v[100:103]
    v_mfma_f32_16x16x32_bf16 v[104:107], a[224:227], v[180:183], v[104:107]
    buffer_load_dwordx4 v[160:163], v10, s[16:19], s21 offen offset:0 sc1
    v_mfma_f32_16x16x32_bf16 v[108:111], a[228:231], v[180:183], v[108:111]
    v_mfma_f32_16x16x32_bf16 v[112:115], a[232:235], v[180:183], v[112:115]
    v_mfma_f32_16x16x32_bf16 v[116:119], a[236:239], v[180:183], v[116:119]
    s_waitcnt vmcnt(18)
    v_mfma_f32_16x16x32_bf16 v[40:43], a[240:243], v[184:187], v[40:43]
    v_mfma_f32_16x16x32_bf16 v[44:47], a[44:47], v[184:187], v[44:47]
    buffer_load_dwordx4 v[164:167], v11, s[16:19], s21 offen offset:0 sc1
    v_mfma_f32_16x16x32_bf16 v[48:51], a[48:51], v[184:187], v[48:51]
    v_mfma_f32_16x16x32_bf16 v[52:55], a[52:55], v[184:187], v[52:55]
    v_mfma_f32_16x16x32_bf16 v[56:59], a[56:59], v[184:187], v[56:59]
    s_waitcnt vmcnt(18)
    v_mfma_f32_16x16x32_bf16 v[60:63], a[240:243], v[188:191], v[60:63]
    v_mfma_f32_16x16x32_bf16 v[64:67], a[44:47], v[188:191], v[64:67]
    buffer_load_dwordx4 v[168:171], v8, s[16:19], s21 offen offset:1024 sc1
    v_mfma_f32_16x16x32_bf16 v[68:71], a[48:51], v[188:191], v[68:71]
    v_mfma_f32_16x16x32_bf16 v[72:75], a[52:55], v[188:191], v[72:75]
    v_mfma_f32_16x16x32_bf16 v[76:79], a[56:59], v[188:191], v[76:79]
    s_waitcnt vmcnt(18)
    v_mfma_f32_16x16x32_bf16 v[80:83], a[240:243], v[192:195], v[80:83]
    v_mfma_f32_16x16x32_bf16 v[84:87], a[44:47], v[192:195], v[84:87]
    buffer_load_dwordx4 v[172:175], v9, s[16:19], s21 offen offset:1024 sc1
    v_mfma_f32_16x16x32_bf16 v[88:91], a[48:51], v[192:195], v[88:91]
    v_mfma_f32_16x16x32_bf16 v[92:95], a[52:55], v[192:195], v[92:95]
    v_mfma_f32_16x16x32_bf16 v[96:99], a[56:59], v[192:195], v[96:99]
    s_waitcnt vmcnt(18)
    v_mfma_f32_16x16x32_bf16 v[100:103], a[240:243], v[196:199], v[100:103]
    v_mfma_f32_16x16x32_bf16 v[104:107], a[44:47], v[196:199], v[104:107]
    buffer_load_dwordx4 v[176:179], v10, s[16:19], s21 offen offset:1024 sc1
    v_mfma_f32_16x16x32_bf16 v[108:111], a[48:51], v[196:199], v[108:111]
    v_mfma_f32_16x16x32_bf16 v[112:115], a[52:55], v[196:199], v[112:115]
    v_mfma_f32_16x16x32_bf16 v[116:119], a[56:59], v[196:199], v[116:119]
    s_waitcnt vmcnt(18)
    v_mfma_f32_16x16x32_bf16 v[40:43], a[60:63], v[200:203], v[40:43]
    v_mfma_f32_16x16x32_bf16 v[44:47], a[64:67], v[200:203], v[44:47]
    buffer_load_dwordx4 v[180:183], v11, s[16:19], s21 offen offset:1024 sc1
    v_mfma_f32_16x16x32_bf16 v[48:51], a[68:71], v[200:203], v[48:51]
    v_mfma_f32_16x16x32_bf16 v[52:55], a[72:75], v[200:203], v[52:55]
    v_mfma_f32_16x16x32_bf16 v[56:59], a[76:79], v[200:203], v[56:59]
    s_waitcnt vmcnt(18)
    v_mfma_f32_16x16x32_bf16 v[60:63], a[60:63], v[204:207], v[60:63]
    v_mfma_f32_16x16x32_bf16 v[64:67], a[64:67], v[204:207], v[64:67]
    buffer_load_dwordx4 v[184:187], v8, s[16:19], s21 offen offset:2048 sc1
    v_mfma_f32_16x16x32_bf16 v[68:71], a[68:71], v[204:207], v[68:71]
    v_mfma_f32_16x16x32_bf16 v[72:75], a[72:75], v[204:207], v[72:75]
    v_mfma_f32_16x16x32_bf16 v[76:79], a[76:79], v[204:207], v[76:79]
    s_waitcnt vmcnt(18)
    v_mfma_f32_16x16x32_bf16 v[80:83], a[60:63], v[208:211], v[80:83]
    v_mfma_f32_16x16x32_bf16 v[84:87], a[64:67], v[208:211], v[84:87]
    buffer_load_dwordx4 v[188:191], v9, s[16:19], s21 offen offset:2048 sc1
    v_mfma_f32_16x16x32_bf16 v[88:91], a[68:71], v[208:211], v[88:91]
    v_mfma_f32_16x16x32_bf16 v[92:95], a[72:75], v[208:211], v[92:95]
    v_mfma_f32_16x16x32_bf16 v[96:99], a[76:79], v[208:211], v[96:99]
    s_waitcnt vmcnt(18)
    v_mfma_f32_16x16x32_bf16 v[100:103], a[60:63], v[212:215], v[100:103]
    v_mfma_f32_16x16x32_bf16 v[104:107], a[64:67], v[212:215], v[104:107]
    buffer_load_dwordx4 v[192:195], v10, s[16:19], s21 offen offset:2048 sc1
    v_mfma_f32_16x16x32_bf16 v[108:111], a[68:71], v[212:215], v[108:111]
    v_mfma_f32_16x16x32_bf16 v[112:115], a[72:75], v[212:215], v[112:115]
    v_mfma_f32_16x16x32_bf16 v[116:119], a[76:79], v[212:215], v[116:119]
    s_waitcnt vmcnt(18)
    v_mfma_f32_16x16x32_bf16 v[40:43], a[80:83], v[120:123], v[40:43]
    v_mfma_f32_16x16x32_bf16 v[44:47], a[84:87], v[120:123], v[44:47]
    buffer_load_dwordx4 v[196:199], v11, s[16:19], s21 offen offset:2048 sc1
    v_mfma_f32_16x16x32_bf16 v[48:51], a[88:91], v[120:123], v[48:51]
    v_mfma_f32_16x16x32_bf16 v[52:55], a[92:95], v[120:123], v[52:55]
    v_mfma_f32_16x16x32_bf16 v[56:59], a[96:99], v[120:123], v[56:59]
    s_waitcnt vmcnt(18)
    v_mfma_f32_16x16x32_bf16 v[60:63], a[80:83], v[124:127], v[60:63]
    v_mfma_f32_16x16x32_bf16 v[64:67], a[84:87], v[124:127], v[64:67]
    buffer_load_dwordx4 v[200:203], v8, s[16:19], s21 offen offset:3072 sc1
    v_mfma_f32_16x16x32_bf16 v[68:71], a[88:91], v[124:127], v[68:71]
    v_mfma_f32_16x16x32_bf16 v[72:75], a[92:95], v[124:127], v[72:75]
    v_mfma_f32_16x16x32_bf16 v[76:79], a[96:99], v[124:127], v[76:79]
    s_waitcnt vmcnt(18)
    v_mfma_f32_16x16x32_bf16 v[80:83], a[80:83], v[128:131], v[80:83]
    v_mfma_f32_16x16x32_bf16 v[84:87], a[84:87], v[128:131], v[84:87]
    buffer_load_dwordx4 v[204:207], v9, s[16:19], s21 offen offset:3072 sc1
    v_mfma_f32_16x16x32_bf16 v[88:91], a[88:91], v[128:131], v[88:91]
    v_mfma_f32_16x16x32_bf16 v[92:95], a[92:95], v[128:131], v[92:95]
    v_mfma_f32_16x16x32_bf16 v[96:99], a[96:99], v[128:131], v[96:99]
    s_waitcnt vmcnt(18)
    v_mfma_f32_16x16x32_bf16 v[100:103], a[80:83], v[132:135], v[100:103]
    v_mfma_f32_16x16x32_bf16 v[104:107], a[84:87], v[132:135], v[104:107]
    buffer_load_dwordx4 v[208:211], v10, s[16:19], s21 offen offset:3072 sc1
    v_mfma_f32_16x16x32_bf16 v[108:111], a[88:91], v[132:135], v[108:111]
    v_mfma_f32_16x16x32_bf16 v[112:115], a[92:95], v[132:135], v[112:115]
    v_mfma_f32_16x16x32_bf16 v[116:119], a[96:99], v[132:135], v[116:119]
    s_waitcnt vmcnt(18)
    v_mfma_f32_16x16x32_bf16 v[40:43], a[100:103], v[136:139], v[40:43]
    v_mfma_f32_16x16x32_bf16 v[44:47], a[104:107], v[136:139], v[44:47]
    buffer_load_dwordx4 v[212:215], v11, s[16:19], s21 offen offset:3072 sc1
    s_add_u32 s21, s21, 4096
    v_mfma_f32_16x16x32_bf16 v[48:51], a[108:111], v[136:139], v[48:51]
    v_mfma_f32_16x16x32_bf16 v[52:55], a[112:115], v[136:139], v[52:55]
    v_mfma_f32_16x16x32_bf16 v[56:59], a[116:119], v[136:139], v[56:59]
    s_waitcnt vmcnt(18)
    v_mfma_f32_16x16x32_bf16 v[60:63], a[100:103], v[140:143], v[60:63]
    v_mfma_f32_16x16x32_bf16 v[64:67], a[104:107], v[140:143], v[64:67]
    v_mfma_f32_16x16x32_bf16 v[68:71], a[108:111], v[140:143], v[68:71]
    v_mfma_f32_16x16x32_bf16 v[72:75], a[112:115], v[140:143], v[72:75]
    v_mfma_f32_16x16x32_bf16 v[76:79], a[116:119], v[140:143], v[76:79]
    s_waitcnt vmcnt(17)
    v_mfma_f32_16x16x32_bf16 v[80:83], a[100:103], v[144:147], v[80:83]
    v_mfma_f32_16x16x32_bf16 v[84:87], a[104:107], v[144:147], v[84:87]
    v_mfma_f32_16x16x32_bf16 v[88:91], a[108:111], v[144:147], v[88:91]
    v_mfma_f32_16x16x32_bf16 v[92:95], a[112:115], v[144:147], v[92:95]
    v_mfma_f32_16x16x32_bf16 v[96:99], a[116:119], v[144:147], v[96:99]
    s_waitcnt vmcnt(16)
    v_mfma_f32_16x16x32_bf16 v[100:103], a[100:103], v[148:151], v[100:103]
    v_mfma_f32_16x16x32_bf16 v[104:107], a[104:107], v[148:151], v[104:107]
    v_mfma_f32_16x16x32_bf16 v[108:111], a[108:111], v[148:151], v[108:111]
    v_mfma_f32_16x16x32_bf16 v[112:115], a[112:115], v[148:151], v[112:115]
    v_mfma_f32_16x16x32_bf16 v[116:119], a[116:119], v[148:151], v[116:119]
    s_waitcnt vmcnt(14)
    v_mfma_f32_16x16x32_bf16 v[60:63], a[120:123], v[156:159], v[60:63]
    v_mfma_f32_16x16x32_bf16 v[64:67], a[124:127], v[156:159], v[64:67]
    v_mfma_f32_16x16x32_bf16 v[68:71], a[128:131], v[156:159], v[68:71]
    v_mfma_f32_16x16x32_bf16 v[72:75], a[132:135], v[156:159], v[72:75]
    v_mfma_f32_16x16x32_bf16 v[76:79], a[136:139], v[156:159], v[76:79]
    s_waitcnt vmcnt(10)
    v_mfma_f32_16x16x32_bf16 v[60:63], a[140:143], v[172:175], v[60:63]
    v_mfma_f32_16x16x32_bf16 v[64:67], a[144:147], v[172:175], v[64:67]
    v_mfma_f32_16x16x32_bf16 v[68:71], a[148:151], v[172:175], v[68:71]
    v_mfma_f32_16x16x32_bf16 v[72:75], a[152:155], v[172:175], v[72:75]
    v_mfma_f32_16x16x32_bf16 v[76:79], a[156:159], v[172:175], v[76:79]
    s_waitcnt vmcnt(6)
    v_mfma_f32_16x16x32_bf16 v[60:63], a[0:3], v[188:191], v[60:63]
    v_mfma_f32_16x16x32_bf16 v[64:67], a[4:7], v[188:191], v[64:67]
    v_mfma_f32_16x16x32_bf16 v[68:71], a[8:11], v[188:191], v[68:71]
    v_mfma_f32_16x16x32_bf16 v[72:75], a[12:15], v[188:191], v[72:75]
    v_mfma_f32_16x16x32_bf16 v[76:79], a[16:19], v[188:191], v[76:79]
    s_waitcnt vmcnt(2)
    v_mfma_f32_16x16x32_bf16 v[60:63], a[20:23], v[204:207], v[60:63]
    v_mfma_f32_16x16x32_bf16 v[64:67], a[24:27], v[204:207], v[64:67]
    v_mfma_f32_16x16x32_bf16 v[68:71], a[28:31], v[204:207], v[68:71]
    v_mfma_f32_16x16x32_bf16 v[72:75], a[32:35], v[204:207], v[72:75]
    v_mfma_f32_16x16x32_bf16 v[76:79], a[36:39], v[204:207], v[76:79]
    v_mfma_f32_16x16x32_bf16 v[80:83], a[120:123], v[160:163], v[80:83]
    v_mfma_f32_16x16x32_bf16 v[84:87], a[124:127], v[160:163], v[84:87]
    s_nop 1
    ds_write_b128 v13, v[60:63] offset:0
    v_mfma_f32_16x16x32_bf16 v[88:91], a[128:131], v[160:163], v[88:91]
    ds_write_b128 v13, v[64:67] offset:1024
    v_mfma_f32_16x16x32_bf16 v[92:95], a[132:135], v[160:163], v[92:95]
    ds_write_b128 v13, v[68:71] offset:2048
    v_mfma_f32_16x16x32_bf16 v[96:99], a[136:139], v[160:163], v[96:99]
    ds_write_b128 v13, v[72:75] offset:3072
    v_mfma_f32_16x16x32_bf16 v[80:83], a[140:143], v[176:179], v[80:83]
    v_mfma_f32_16x16x32_bf16 v[84:87], a[144:147], v[176:179], v[84:87]
    ds_write_b128 v13, v[76:79] offset:4096
    v_mfma_f32_16x16x32_bf16 v[88:91], a[148:151], v[176:179], v[88:91]
    v_mfma_f32_16x16x32_bf16 v[92:95], a[152:155], v[176:179], v[92:95]
    v_mfma_f32_16x16x32_bf16 v[96:99], a[156:159], v[176:179], v[96:99]
    v_mfma_f32_16x16x32_bf16 v[80:83], a[0:3], v[192:195], v[80:83]
    v_mfma_f32_16x16x32_bf16 v[84:87], a[4:7], v[192:195], v[84:87]
    v_mfma_f32_16x16x32_bf16 v[88:91], a[8:11], v[192:195], v[88:91]
    v_mfma_f32_16x16x32_bf16 v[92:95], a[12:15], v[192:195], v[92:95]
    v_mfma_f32_16x16x32_bf16 v[96:99], a[16:19], v[192:195], v[96:99]
    s_waitcnt vmcnt(1)
    v_mfma_f32_16x16x32_bf16 v[80:83], a[20:23], v[208:211], v[80:83]
    v_mfma_f32_16x16x32_bf16 v[84:87], a[24:27], v[208:211], v[84:87]
    v_mfma_f32_16x16x32_bf16 v[88:91], a[28:31], v[208:211], v[88:91]
    v_mfma_f32_16x16x32_bf16 v[92:95], a[32:35], v[208:211], v[92:95]
    v_mfma_f32_16x16x32_bf16 v[96:99], a[36:39], v[208:211], v[96:99]
    v_mfma_f32_16x16x32_bf16 v[100:103], a[120:123], v[164:167], v[100:103]
    v_mfma_f32_16x16x32_bf16 v[104:107], a[124:127], v[164:167], v[104:107]
    s_nop 1
    ds_write_b128 v13, v[80:83] offset:5120
    v_mfma_f32_16x16x32_bf16 v[108:111], a[128:131], v[164:167], v[108:111]
    ds_write_b128 v13, v[84:87] offset:6144
    v_mfma_f32_16x16x32_bf16 v[112:115], a[132:135], v[164:167], v[112:115]
    ds_write_b128 v13, v[88:91] offset:7168
    v_mfma_f32_16x16x32_bf16 v[116:119], a[136:139], v[164:167], v[116:119]
    ds_write_b128 v13, v[92:95] offset:8192
    v_mfma_f32_16x16x32_bf16 v[100:103], a[140:143], v[180:183], v[100:103]
    v_mfma_f32_16x16x32_bf16 v[104:107], a[144:147], v[180:183], v[104:107]
    ds_write_b128 v13, v[96:99] offset:9216
    v_mfma_f32_16x16x32_bf16 v[108:111], a[148:151], v[180:183], v[108:111]
    v_mfma_f32_16x16x32_bf16 v[112:115], a[152:155], v[180:183], v[112:115]
    v_mfma_f32_16x16x32_bf16 v[116:119], a[156:159], v[180:183], v[116:119]
    v_mfma_f32_16x16x32_bf16 v[100:103], a[0:3], v[196:199], v[100:103]
    v_mfma_f32_16x16x32_bf16 v[104:107], a[4:7], v[196:199], v[104:107]
    v_mfma_f32_16x16x32_bf16 v[108:111], a[8:11], v[196:199], v[108:111]
    v_mfma_f32_16x16x32_bf16 v[112:115], a[12:15], v[196:199], v[112:115]
    v_mfma_f32_16x16x32_bf16 v[116:119], a[16:19], v[196:199], v[116:119]
    s_waitcnt vmcnt(0)
    v_mfma_f32_16x16x32_bf16 v[100:103], a[20:23], v[212:215], v[100:103]
    v_mfma_f32_16x16x32_bf16 v[104:107], a[24:27], v[212:215], v[104:107]
    v_mfma_f32_16x16x32_bf16 v[108:111], a[28:31], v[212:215], v[108:111]
    v_mfma_f32_16x16x32_bf16 v[112:115], a[32:35], v[212:215], v[112:115]
    v_mfma_f32_16x16x32_bf16 v[116:119], a[36:39], v[212:215], v[116:119]
    v_mfma_f32_16x16x32_bf16 v[40:43], a[120:123], v[152:155], v[40:43]
    v_mfma_f32_16x16x32_bf16 v[44:47], a[124:127], v[152:155], v[44:47]
    s_nop 1
    ds_write_b128 v13, v[100:103] offset:10240
    v_mfma_f32_16x16x32_bf16 v[48:51], a[128:131], v[152:155], v[48:51]
    ds_write_b128 v13, v[104:107] offset:11264
    v_mfma_f32_16x16x32_bf16 v[52:55], a[132:135], v[152:155], v[52:55]
    ds_write_b128 v13, v[108:111] offset:12288
    v_mfma_f32_16x16x32_bf16 v[56:59], a[136:139], v[152:155], v[56:59]
    ds_write_b128 v13, v[112:115] offset:13312
    v_mfma_f32_16x16x32_bf16 v[40:43], a[140:143], v[168:171], v[40:43]
    v_mfma_f32_16x16x32_bf16 v[44:47], a[144:147], v[168:171], v[44:47]
    ds_write_b128 v13, v[116:119] offset:14336
    v_mfma_f32_16x16x32_bf16 v[48:51], a[148:151], v[168:171], v[48:51]
    v_mfma_f32_16x16x32_bf16 v[52:55], a[152:155], v[168:171], v[52:55]
    v_mfma_f32_16x16x32_bf16 v[56:59], a[156:159], v[168:171], v[56:59]
    s_waitcnt lgkmcnt(0)
    s_barrier
    ds_read_b128 v[124:127], v14 offset:0
    ds_read_b128 v[128:131], v15 offset:0
    ds_read_b128 v[132:135], v16 offset:0
    ds_read_b128 v[140:143], v14 offset:1024
    ds_read_b128 v[144:147], v15 offset:1024
    ds_read_b128 v[148:151], v16 offset:1024
    ds_read_b128 v[156:159], v14 offset:2048
    ds_read_b128 v[160:163], v15 offset:2048
    ds_read_b128 v[164:167], v16 offset:2048
    ds_read_b128 v[172:175], v14 offset:3072
    ds_read_b128 v[176:179], v15 offset:3072
    ds_read_b128 v[180:183], v16 offset:3072
    ds_read_b128 v[188:191], v14 offset:4096
    ds_read_b128 v[192:195], v15 offset:4096
    ds_read_b128 v[196:199], v16 offset:4096
    v_mfma_f32_16x16x32_bf16 v[40:43], a[0:3], v[184:187], v[40:43]
    v_mfma_f32_16x16x32_bf16 v[44:47], a[4:7], v[184:187], v[44:47]
    v_mfma_f32_16x16x32_bf16 v[48:51], a[8:11], v[184:187], v[48:51]
    v_mfma_f32_16x16x32_bf16 v[52:55], a[12:15], v[184:187], v[52:55]
    v_mfma_f32_16x16x32_bf16 v[56:59], a[16:19], v[184:187], v[56:59]
    v_mfma_f32_16x16x32_bf16 v[40:43], a[20:23], v[200:203], v[40:43]
    v_mfma_f32_16x16x32_bf16 v[44:47], a[24:27], v[200:203], v[44:47]
    v_mfma_f32_16x16x32_bf16 v[48:51], a[28:31], v[200:203], v[48:51]
    v_mfma_f32_16x16x32_bf16 v[52:55], a[32:35], v[200:203], v[52:55]
    v_mfma_f32_16x16x32_bf16 v[56:59], a[36:39], v[200:203], v[56:59]
    s_waitcnt lgkmcnt(12)
    v_pk_add_f32 v[124:125], v[124:125], v[128:129]
    v_pk_add_f32 v[126:127], v[126:127], v[130:131]
    v_pk_add_f32 v[232:233], v[232:233], v[132:133]
    v_pk_add_f32 v[234:235], v[234:235], v[134:135]
    v_pk_add_f32 v[232:233], v[232:233], v[124:125]
    v_pk_add_f32 v[234:235], v[234:235], v[126:127]
    v_pk_add_f32 v[232:233], v[232:233], v[40:41]
    v_pk_add_f32 v[234:235], v[234:235], v[42:43]
    v_cvt_pk_bf16_f32 v20, v232, v233
    v_cvt_pk_bf16_f32 v21, v234, v235
    s_waitcnt lgkmcnt(9)
    v_pk_add_f32 v[140:141], v[140:141], v[144:145]
    v_pk_add_f32 v[142:143], v[142:143], v[146:147]
    v_pk_add_f32 v[236:237], v[236:237], v[148:149]
    v_pk_add_f32 v[238:239], v[238:239], v[150:151]
    v_pk_add_f32 v[236:237], v[236:237], v[140:141]
    v_pk_add_f32 v[238:239], v[238:239], v[142:143]
    v_pk_add_f32 v[236:237], v[236:237], v[44:45]
    v_pk_add_f32 v[238:239], v[238:239], v[46:47]
    v_cvt_pk_bf16_f32 v22, v236, v237
    v_cvt_pk_bf16_f32 v23, v238, v239
    s_nop 0
    v_permlane16_swap_b32 v20, v22
    v_permlane16_swap_b32 v21, v23
    buffer_store_dwordx4 v[20:23], v6, s[8:11], s34 offen offset:0
    s_waitcnt lgkmcnt(6)
    v_pk_add_f32 v[156:157], v[156:157], v[160:161]
    v_pk_add_f32 v[158:159], v[158:159], v[162:163]
    v_pk_add_f32 v[240:241], v[240:241], v[164:165]
    v_pk_add_f32 v[242:243], v[242:243], v[166:167]
    v_pk_add_f32 v[240:241], v[240:241], v[156:157]
    v_pk_add_f32 v[242:243], v[242:243], v[158:159]
    v_pk_add_f32 v[240:241], v[240:241], v[48:49]
    v_pk_add_f32 v[242:243], v[242:243], v[50:51]
    v_cvt_pk_bf16_f32 v24, v240, v241
    v_cvt_pk_bf16_f32 v25, v242, v243
    s_waitcnt lgkmcnt(3)
    v_pk_add_f32 v[172:173], v[172:173], v[176:177]
    v_pk_add_f32 v[174:175], v[174:175], v[178:179]
    v_pk_add_f32 v[244:245], v[244:245], v[180:181]
    v_pk_add_f32 v[246:247], v[246:247], v[182:183]
    v_pk_add_f32 v[244:245], v[244:245], v[172:173]
    v_pk_add_f32 v[246:247], v[246:247], v[174:175]
    v_pk_add_f32 v[244:245], v[244:245], v[52:53]
    v_pk_add_f32 v[246:247], v[246:247], v[54:55]
    v_cvt_pk_bf16_f32 v26, v244, v245
    v_cvt_pk_bf16_f32 v27, v246, v247
    s_nop 0
    v_permlane16_swap_b32 v24, v26
    v_permlane16_swap_b32 v25, v27
    buffer_store_dwordx4 v[24:27], v6, s[8:11], s34 offen offset:64
    s_waitcnt lgkmcnt(0)
    v_pk_add_f32 v[188:189], v[188:189], v[192:193]
    v_pk_add_f32 v[190:191], v[190:191], v[194:195]
    v_pk_add_f32 v[248:249], v[248:249], v[196:197]
    v_pk_add_f32 v[250:251], v[250:251], v[198:199]
    v_pk_add_f32 v[248:249], v[248:249], v[188:189]
    v_pk_add_f32 v[250:251], v[250:251], v[190:191]
    v_pk_add_f32 v[248:249], v[248:249], v[56:57]
    v_pk_add_f32 v[250:251], v[250:251], v[58:59]
    v_cvt_pk_bf16_f32 v28, v248, v249
    v_cvt_pk_bf16_f32 v29, v250, v251
    buffer_store_dwordx2 v[28:29], v7, s[8:11], s34 offen offset:128
kend:
    s_endpgm
.section .rodata,"a"
.p2align 6
.amdhsa_kernel sequential_preLN__linear_attn_block__dense_activation_squared_relu__prompt_kernel
  .amdhsa_next_free_vgpr 512
  .amdhsa_next_free_sgpr 102
  .amdhsa_accum_offset 256
  .amdhsa_group_segment_fixed_size 0
  .amdhsa_kernarg_size 88
  .amdhsa_user_sgpr_count 2
  .amdhsa_user_sgpr_kernarg_segment_ptr 1
  .amdhsa_system_sgpr_workgroup_id_x 1
.end_amdhsa_kernel
```
